```python
import torch

def _softmax(x, axis=-1):
    return torch.softmax(x, dim=axis)

def _gelu(x):
    return torch.nn.functional.gelu(x, approximate='tanh')

def _silu(x):
    return torch.nn.functional.silu(x)

def _sigmoid(x):
    return torch.sigmoid(x)

def _layernorm(x, axis=-1, eps=1e-05):
    m = x.mean(dim=axis, keepdim=True)
    v = x.var(dim=axis, keepdim=True, unbiased=False)
    return (x - m) / torch.sqrt(v + eps)

def _scatter_add(tgt, idx, src, axis=0):
    return tgt.clone().index_add_(axis, idx, src)

def _segment_sum(src, seg, n):
    out = torch.zeros((n,) + src.shape[1:], dtype=src.dtype)
    return out.index_add_(0, seg, src)

def _pad(x, pw):
    flat = tuple((v for pair in reversed(pw) for v in pair))
    return torch.nn.functional.pad(x, flat)
kernel_name = 'recurrent_scan__linear_kernel_hedgehog__mixer_gmlp__prompt'

def setup_inputs():

    _w = lambda a: (lambda t: t.to(torch.bfloat16) if t.is_floating_point() else t)(torch.as_tensor(a))

    def _A_setup():
        B, S, D, H = (1, 2048, 512, 32)
        Dh = D // H
        return {'x': _w((lambda *s: torch.randn(*s, dtype=torch.bfloat16) * 0.05)(B, S, D)), 'wqkv': _w((lambda *s: torch.randn(*s, dtype=torch.bfloat16) * 0.2)(D, 3 * D)), 'w_phi': _w((lambda *s: torch.randn(*s, dtype=torch.bfloat16) * 0.2)(H, Dh, Dh) * Dh ** (-0.5)), 'wo': _w((lambda *s: torch.randn(*s, dtype=torch.bfloat16) * 0.05)(D, D))}
    _A_in = _A_setup()

    def _B_setup():
        B, S, D, F = (1, 2048, 512, 1376)
        Fh = F // 2
        return {'x': _w((lambda *s: torch.randn(*s, dtype=torch.bfloat16) * 0.05)(B, S, D)), 'w_in': _w((lambda *s: torch.randn(*s, dtype=torch.bfloat16) * 0.4)(D, 2 * Fh)), 'w_sp': _w(0.01 * (lambda *s: torch.randn(*s, dtype=torch.bfloat16) * 0.4)(S, S)), 'b_sp': _w(1.0 + 0.01 * (lambda *s: torch.randn(*s, dtype=torch.bfloat16) * 0.05)(S)), 'w_out': _w((lambda *s: torch.randn(*s, dtype=torch.bfloat16) * 0.05)(Fh, D))}
    _B_in = _B_setup()
    return {'A_x': _A_in['x'], 'A_wqkv': _A_in['wqkv'], 'A_w_phi': _A_in['w_phi'], 'A_wo': _A_in['wo'], 'B_x': _B_in['x'], 'B_w_in': _B_in['w_in'], 'B_w_sp': _B_in['w_sp'], 'B_b_sp': _B_in['b_sp'], 'B_w_out': _B_in['w_out']}

def reference(A_x, A_wqkv, A_w_phi, A_wo, B_x, B_w_in, B_w_sp, B_b_sp, B_w_out):

    def _A_ref(x, wqkv, w_phi, wo):
        B, S, D = x.shape
        H = 32
        Dh = D // H
        qkv = (lambda x, *d: x.permute(*d))((x @ wqkv).reshape(B, S, 3, H, Dh), 2, 0, 3, 1, 4)
        q, k, v = (qkv[0], qkv[1], qkv[2])
        pq = torch.einsum('bhsd,hdf->bhsf', q, w_phi)
        pk = torch.einsum('bhsd,hdf->bhsf', k, w_phi)
        phi_q = torch.concatenate([_softmax(pq, axis=-1), _softmax(-pq, axis=-1)], axis=-1)
        phi_k = torch.concatenate([_softmax(pk, axis=-1), _softmax(-pk, axis=-1)], axis=-1)
        kv = torch.einsum('bhsf,bhsd->bhfd', phi_k, v)
        z = torch.einsum('bhsf->bhf', phi_k)
        num = torch.einsum('bhqf,bhfd->bhqd', phi_q, kv)
        den = torch.einsum('bhqf,bhf->bhq', phi_q, z)[..., None] + 1e-06
        o = num / den
        return (lambda x, *d: x.permute(*d))(o, 0, 2, 1, 3).reshape(B, S, D) @ wo

    def _B_ref(x, w_in, w_sp, b_sp, w_out):
        B, S, D = x.shape
        F = w_in.shape[-1]
        Fh = F // 2
        z = _gelu(torch.einsum('bsd,df->bsf', x, w_in))
        z1 = z[..., :Fh].clone()
        z2 = _layernorm(z[..., Fh:], axis=-1)
        g = torch.einsum('ts,bsf->btf', w_sp, z2) + b_sp[None, :, None]
        return torch.einsum('bsf,fd->bsd', z1 * g, w_out)
    x = A_x
    xn = _layernorm(x, axis=-1)
    s = _A_ref(xn, A_wqkv, A_w_phi, A_wo)
    g = _silu(_B_ref(xn, B_w_in, B_w_sp, B_b_sp, B_w_out))
    return x + s * g
```

```asm
; @launch grid=(256,1,1) block=(256,1,1) lds=163840
.amdgcn_target "amdgcn-amd-amdhsa--gfx950"
.text
.globl recurrent_scan__linear_kernel_hedgehog__mixer_gmlp__prompt_kernel
.p2align 8
.type recurrent_scan__linear_kernel_hedgehog__mixer_gmlp__prompt_kernel,@function
recurrent_scan__linear_kernel_hedgehog__mixer_gmlp__prompt_kernel:
    s_cmp_ge_u32 s2, 256
    s_cbranch_scc1 L_end
    s_load_dwordx2 s[4:5], s[0:1], 0
    s_load_dwordx2 s[12:13], s[0:1], 40
    s_load_dwordx2 s[20:21], s[0:1], 88
    s_load_dwordx2 s[8:9], s[0:1], 8
    s_load_dwordx2 s[16:17], s[0:1], 48
    s_load_dwordx2 s[24:25], s[0:1], 72
    s_load_dwordx2 s[28:29], s[0:1], 24
    s_load_dwordx2 s[32:33], s[0:1], 64
    s_load_dwordx2 s[36:37], s[0:1], 16
    s_load_dwordx2 s[40:41], s[0:1], 56
    v_lshrrev_b32 v2, 6, v0
    v_and_b32 v1, 63, v0
    s_lshr_b32 s68, s2, 3
    v_readfirstlane_b32 s48, v2
    v_lshlrev_b32 v0, 4, v1
    s_getpc_b64 s[76:77]
L_pc:
    s_lshl_b32 s69, s68, 2
    s_add_u32 s69, s69, s48
    s_and_b32 s69, s69, 63
    s_min_u32 s69, s69, (L_end-L_pc)/1024
    s_lshl_b32 s69, s69, 10
    v_add_u32 v2, s69, v0
    global_load_dwordx4 v[12:15], v2, s[76:77]
    s_and_b32 s69, s2, 1
    s_lshl_b32 s69, s69, 3
    s_lshr_b32 s70, s68, 2
    s_add_u32 s49, s69, s70
    s_and_b32 s71, s68, 3
    s_lshl_b32 s71, s71, 1
    s_add_u32 s52, s70, s71
    s_and_b32 s52, s52, 4
    s_lshl_b32 s52, s52, 7
    s_lshl_b32 s54, s48, 15
    s_lshl_b32 s63, s49, 2
    s_add_u32 s63, s63, s48
    s_lshl_b32 s56, s63, 15
    v_lshrrev_b32 v2, 3, v1
    v_lshrrev_b32 v3, 4, v1
    v_and_b32 v4, 7, v1
    v_xor_b32 v5, v4, v3
    v_lshlrev_b32 v5, 4, v5
    v_lshl_add_u32 v16, v2, 10, v5
    v_xor_b32 v6, 64, v16
    v_add_u32 v17, 7168, v6
    v_add_u32 v18, 14336, v16
    v_add_u32 v19, 21504, v6
    s_bfe_u32 s69, s2, 0x20001
    s_lshl_b32 s69, s69, 1
    s_bfe_u32 s71, s68, 0x10001
    s_add_u32 s50, s69, s71
    s_and_b32 s75, s68, 1
    s_xor_b32 s51, s75, 1
    s_lshl_b32 s79, s50, 1
    s_add_u32 s79, s79, s75
    s_lshl_b32 s79, s79, 2
    s_add_u32 s79, s79, s48
    s_lshl_b32 s69, s49, 6
    s_add_u32 s79, s79, s69
    s_lshl_b32 s69, s50, 1
    s_add_u32 s71, s69, 27
    s_add_u32 s72, s69, 11
    s_lshl_b32 s73, s50, 2
    s_cmp_le_u32 s50, 4
    s_cselect_b32 s72, s73, s72
    s_cselect_b32 s61, 0, 1
    s_cmp_eq_u32 s51, 1
    s_cselect_b32 s72, s71, s72
    s_cselect_b32 s61, 1, s61
    s_lshl_b32 s73, s72, 6
    s_lshl_b32 s74, s50, 7
    s_lshl_b32 s71, s51, 10
    s_add_u32 s74, s74, s71
    s_movk_i32 s59, 2752
    s_cmp_lt_u32 s48, 2
    s_cselect_b32 s58, s73, s74
    s_cselect_b32 s59, s59, 3072
    s_and_b32 s71, s48, 1
    s_lshl_b32 s71, s71, 5
    s_mul_i32 s71, s71, s59
    s_add_u32 s58, s58, s71
    s_lshl_b32 s3, s48, 11
    s_lshl_b32 s46, s59, 9
    s_mov_b32 s47, 0x00020000
    v_and_b32 v6, 1, v3
    v_lshlrev_b32 v6, 2, v6
    v_xor_b32 v6, v6, v4
    v_lshlrev_b32 v24, 4, v6
    v_mul_lo_u32 v7, v2, s59
    v_add_u32 v26, v7, v24
    s_lshl_b32 s71, s59, 3
    s_sub_u32 s71, s71, 1024
    s_lshr_b32 s59, s59, 1
    v_add_u32 v27, s71, v26
    v_add_u32 v28, s71, v27
    v_add_u32 v29, s71, v28
    v_lshrrev_b32 v57, 5, v1
    v_min_u32 v61, 1, v1
    v_lshlrev_b32 v61, 30, v61
    v_lshl_add_u32 v8, v57, 9, v0
    s_lshl_b32 s69, s79, 11
    s_mov_b32 s6, 2097152
    s_mov_b32 s7, 0x00020000
    s_mov_b32 s22, 13631488
    s_mov_b32 s23, 0x00020000
    s_cmp_lt_u32 s48, 2
    s_waitcnt lgkmcnt(0)
    s_cselect_b32 s44, s12, s8
    s_cselect_b32 s45, s13, s9
    buffer_load_dwordx4 v[208:211], v8, s[4:7], s69 offen
    buffer_load_dwordx4 v[212:215], v8, s[4:7], s69 offen offset:512
    buffer_load_dword v56, v61, s[20:23], 0 offen sc1
    s_add_u32 s73, s52, 0
    s_and_b32 s73, s73, 0x3ff
    s_or_b32 s74, s73, s56
    s_add_u32 m0, s54, 0
    s_mul_i32 s75, s73, s59
    buffer_load_dwordx4 v16, s[4:7], s74 offen offset:0 lds
    buffer_load_dwordx4 v17, s[4:7], s74 offen offset:1024 lds
    buffer_load_dwordx4 v18, s[4:7], s74 offen offset:2048 lds
    buffer_load_dwordx4 v19, s[4:7], s74 offen offset:3072 lds
    s_add_u32 m0, s54, 16384
    s_add_u32 s75, s75, s58
    buffer_load_dwordx4 v26, s[44:47], s75 offen offset:0 lds
    buffer_load_dwordx4 v27, s[44:47], s75 offen offset:1024 lds
    buffer_load_dwordx4 v28, s[44:47], s75 offen offset:2048 lds
    buffer_load_dwordx4 v29, s[44:47], s75 offen offset:3072 lds
    s_mov_b32 s55, 0x3f803f80
    s_mov_b32 s60, s72
    v_and_b32 v7, 31, v1
    v_lshlrev_b32 v8, 7, v7
    v_add_u32 v8, s54, v8
    v_bfe_u32 v9, v1, 1, 3
    v_xor_b32 v9, v9, v57
    v_lshlrev_b32 v9, 4, v9
    v_xor_b32 v10, 0, v9
    v_add_u32 v20, v8, v10
    v_xor_b32 v10, 32, v9
    v_add_u32 v21, v8, v10
    v_xor_b32 v10, 64, v9
    v_add_u32 v22, v8, v10
    v_xor_b32 v10, 96, v9
    v_add_u32 v23, v8, v10
    v_bfe_u32 v7, v1, 2, 2
    v_lshl_add_u32 v8, v57, 3, v7
    v_lshlrev_b32 v8, 7, v8
    v_bfe_u32 v9, v1, 3, 1
    v_lshl_add_u32 v8, v9, 6, v8
    v_bfe_u32 v9, v1, 4, 1
    v_lshl_add_u32 v8, v9, 5, v8
    v_and_b32 v9, 3, v1
    v_lshl_add_u32 v34, v9, 3, v8
    v_xor_b32 v35, 64, v34
    v_add_u32 v36, 0x10000, v34
    v_add_u32 v37, 0x10000, v35
    v_add_u32 v38, s54, v34
    v_add_u32 v39, s54, v35
    v_mov_b32 v40, 0
    v_mov_b32 v41, 0
    s_lshr_b32 s68, s2, 3
    s_and_b32 s69, s2, 3
    s_lshl_b32 s69, s69, 3
    s_lshr_b32 s70, s68, 2
    s_add_u32 s66, s69, s70
    s_bfe_u32 s69, s2, 0x10002
    s_lshl_b32 s69, s69, 2
    s_and_b32 s71, s68, 3
    s_add_u32 s67, s69, s71
    s_cmp_eq_u32 s60, 21
    s_cselect_b32 s62, 0, 1.0
    s_mul_i32 s68, s63, 44
    s_lshl_b32 s69, s60, 1
    s_add_u32 s64, s68, s69
    s_lshl_b32 s64, s64, 10
    s_add_u32 s64, s64, 4194304
    s_sub_u32 s60, s60, 21
    s_lshr_b32 s60, s60, 1
    s_lshl_b32 s70, s50, 2
    s_add_u32 s70, s70, 2
    s_min_u32 s70, s70, 20
    s_lshl_b32 s69, s70, 1
    s_add_u32 s65, s68, s69
    s_lshl_b32 s65, s65, 10
    s_add_u32 s65, s65, 4194304
    s_lshl_b32 s70, s70, 6
    s_cmp_ge_u32 s50, 6
    s_cselect_b32 s70, 1073741824, s70
    s_cselect_b32 s65, 1073741824, s65
    s_lshl_b32 s69, s50, 7
    s_add_u32 s69, s69, 2048
    s_movk_i32 s71, 2752
    s_cmp_eq_u32 s51, 1
    s_cselect_b32 s57, s69, s70
    s_cselect_b32 s71, 3072, s71
    s_cselect_b32 s8, s8, s12
    s_cselect_b32 s9, s9, s13
    s_lshl_b32 s10, s71, 9
    s_mov_b32 s11, 0x00020000
    s_lshl_b32 s69, s48, 4
    s_mul_i32 s69, s69, s71
    s_add_u32 s57, s57, s69
    v_lshrrev_b32 v8, 3, v1
    v_mul_lo_u32 v8, v8, s71
    v_add_u32 v24, v8, v24
    s_lshr_b32 s12, s71, 1
    s_lshl_b32 s71, s71, 3
    s_sub_u32 s71, s71, 1024
    v_add_u32 v25, s71, v24
    v_and_b32 v8, 31, v1
    v_lshlrev_b32 v43, 5, v8
    v_add_u32 v43, 131072, v43
    s_lshl_b32 s71, s48, 3
    v_lshl_add_u32 v42, v57, 2, v43
    v_add_u32 v42, s71, v42
    v_add_u32 v30, 131072, v34
    v_add_u32 v31, 131072, v35
    v_add_u32 v32, s3, v30
    v_add_u32 v33, s3, v31
    v_mov_b32 v60, 1073741824
    v_mov_b32 v54, 0
    v_mov_b32 v55, 0
    s_mov_b32 s18, 8388608
    s_mov_b32 s19, 0x00020000
    s_mov_b32 s26, 2097152
    s_mov_b32 s27, 0x00020000
    s_mov_b32 s30, 524288
    s_mov_b32 s31, 0x00020000
    s_mov_b32 s34, 704512
    s_mov_b32 s35, 0x00020000
    s_mov_b32 s38, 16384
    s_mov_b32 s39, 0x00020000
    s_mov_b32 s42, 4096
    s_mov_b32 s43, 0x00020000
    s_lshl_b32 s68, s66, 1
    s_and_b32 s69, s48, 1
    s_add_u32 s68, s68, s69
    s_lshl_b32 s78, s68, 15
    s_lshl_b32 s68, s67, 7
    s_add_u32 s78, s78, s68
    s_lshr_b32 s70, s48, 1
    s_lshl_b32 s68, s70, 6
    s_add_u32 s78, s78, s68
    v_and_b32 v7, 31, v1
    v_lshlrev_b32 v8, 10, v7
    v_lshl_add_u32 v62, v57, 3, v8
    v_lshlrev_b32 v8, 4, v7
    v_add_u32 v254, 155648, v8
    s_lshl_b32 s70, s70, 10
    s_lshl_b32 s69, s69, 3
    s_add_u32 s69, s69, s70
    v_lshl_add_u32 v255, v57, 2, v254
    v_add_u32 v255, s69, v255
    s_lshl_b32 s71, s48, 12
    s_add_u32 s72, s54, 12288
    v_lshlrev_b32 v10, 6, v7
    v_bfe_u32 v11, v1, 1, 3
    v_xor_b32 v11, v11, v57
    v_lshl_add_u32 v10, v11, 3, v10
    v_add_u32 v45, s72, v10
    v_xor_b32 v47, 16, v45
    v_xor_b32 v49, 32, v45
    v_xor_b32 v51, 48, v45
    v_bfe_u32 v10, v1, 2, 2
    v_lshl_add_u32 v10, v57, 3, v10
    v_lshlrev_b32 v10, 6, v10
    v_bfe_u32 v11, v1, 4, 1
    v_xor_b32 v11, v11, v57
    v_lshlrev_b32 v11, 2, v11
    v_and_b32 v9, 3, v1
    v_bfe_u32 v8, v1, 3, 1
    v_xor_b32 v9, v9, v8
    v_or_b32 v11, v11, v9
    v_lshl_add_u32 v10, v11, 3, v10
    v_add_u32 v10, s72, v10
    v_xor_b32 v11, 16, v10
    v_add_u32 v11, 256, v11
    v_accvgpr_write_b32 a249, v10
    v_accvgpr_write_b32 a250, v11
    v_lshlrev_b32 v8, 7, v7
    s_add_u32 s71, s71, 131072
    v_bfe_u32 v9, v1, 1, 1
    v_xor_b32 v9, v9, v57
    v_lshlrev_b32 v9, 2, v9
    v_bfe_u32 v10, v1, 2, 1
    v_lshl_or_b32 v9, v10, 1, v9
    v_and_b32 v10, 1, v1
    v_or_b32 v9, v9, v10
    v_lshl_add_u32 v8, v9, 4, v8
    v_add_u32 v63, s71, v8
    v_and_b32 v4, 1, v1
    v_lshlrev_b32 v4, 9, v4
    v_lshl_add_u32 v4, v57, 7, v4
    v_bfe_u32 v5, v1, 2, 2
    v_lshl_add_u32 v4, v5, 5, v4
    v_bfe_u32 v5, v1, 4, 1
    v_lshl_add_u32 v4, v5, 4, v4
    v_bfe_u32 v5, v1, 1, 1
    v_lshl_add_u32 v4, v5, 3, v4
    v_add_u32 v4, s3, v4
    v_add_u32 v59, 131072, v4
    s_add_u32 s73, s52, 128
    s_and_b32 s73, s73, 0x3ff
    s_or_b32 s74, s73, s56
    s_add_u32 m0, s54, 4096
    s_mul_i32 s75, s73, s59
    buffer_load_dwordx4 v16, s[4:7], s74 offen offset:0 lds
    s_waitcnt vmcnt(9)
    v_readfirstlane_b32 s53, v56
    v_mov_b32 v2, 0
    v_mov_b32 v3, 0
    v_dot2c_f32_bf16 v2, s55, v208
    v_dot2c_f32_bf16 v3, v208, v208
    v_dot2c_f32_bf16 v2, s55, v209
    buffer_load_dwordx4 v17, s[4:7], s74 offen offset:1024 lds
    v_dot2c_f32_bf16 v3, v209, v209
    v_dot2c_f32_bf16 v2, s55, v210
    v_dot2c_f32_bf16 v3, v210, v210
    v_dot2c_f32_bf16 v2, s55, v211
    v_dot2c_f32_bf16 v3, v211, v211
    v_dot2c_f32_bf16 v2, s55, v212
    buffer_load_dwordx4 v18, s[4:7], s74 offen offset:2048 lds
    v_dot2c_f32_bf16 v3, v212, v212
    v_dot2c_f32_bf16 v2, s55, v213
    v_dot2c_f32_bf16 v3, v213, v213
    v_dot2c_f32_bf16 v2, s55, v214
    v_dot2c_f32_bf16 v3, v214, v214
    v_dot2c_f32_bf16 v2, s55, v215
    buffer_load_dwordx4 v19, s[4:7], s74 offen offset:3072 lds
    v_dot2c_f32_bf16 v3, v215, v215
    s_add_u32 s53, s53, 2654435761
    s_lshl_b32 s69, s79, 7
    s_add_u32 s69, s69, 13107200
    s_nop 0
    v_add_f32_dpp v2, v2, v2 row_ror:8 row_mask:0xf bank_mask:0xf
    v_add_f32_dpp v3, v3, v3 row_ror:8 row_mask:0xf bank_mask:0xf
    s_nop 0
    v_add_f32_dpp v2, v2, v2 row_ror:4 row_mask:0xf bank_mask:0xf
    v_add_f32_dpp v3, v3, v3 row_ror:4 row_mask:0xf bank_mask:0xf
    s_nop 0
    v_add_f32_dpp v2, v2, v2 row_ror:2 row_mask:0xf bank_mask:0xf
    s_add_u32 m0, s54, 20480
    s_add_u32 s75, s75, s58
    buffer_load_dwordx4 v26, s[44:47], s75 offen offset:0 lds
    v_add_f32_dpp v3, v3, v3 row_ror:2 row_mask:0xf bank_mask:0xf
    s_nop 0
    v_add_f32_dpp v2, v2, v2 row_ror:1 row_mask:0xf bank_mask:0xf
    v_add_f32_dpp v3, v3, v3 row_ror:1 row_mask:0xf bank_mask:0xf
    s_nop 1
    v_permlane16_swap_b32 v2, v3
    v_add_f32 v3, v2, v3
    buffer_load_dwordx4 v27, s[44:47], s75 offen offset:1024 lds
    v_mov_b32 v2, v3
    s_nop 1
    v_permlane16_swap_b32 v2, v3
    v_mul_f32 v212, 0xbb000000, v2
    v_mul_f32 v3, 0x3b000000, v3
    v_fma_f32 v3, -v212, v212, v3
    buffer_load_dwordx4 v28, s[44:47], s75 offen offset:2048 lds
    v_max_f32 v3, 0, v3
    v_add_f32 v3, 0x3727c5ac, v3
    v_rsq_f32 v213, v3
    v_and_b32 v8, 31, v1
    v_mul_f32 v214, v3, v213
    buffer_load_dwordx4 v29, s[44:47], s75 offen offset:3072 lds
    v_mov_b32 v215, s53
    v_min_u32 v8, 1, v8
    v_lshlrev_b32 v8, 30, v8
    v_lshl_add_u32 v8, v57, 4, v8
    s_mov_b32 s82, s69
    v_mov_b32 v216, v8
    s_waitcnt vmcnt(8)
    ds_read_b64_tr_b16 v[192:193], v38 offset:16384
    s_add_u32 s73, s52, 256
    s_and_b32 s73, s73, 0x3ff
    s_or_b32 s74, s73, s56
    s_add_u32 m0, s54, 8192
    ds_read_b64_tr_b16 v[194:195], v38 offset:16896
    s_mul_i32 s75, s73, s59
    ds_read_b64_tr_b16 v[196:197], v38 offset:18432
    buffer_load_dwordx4 v16, s[4:7], s74 offen offset:0 lds
    ds_read_b64_tr_b16 v[198:199], v38 offset:18944
    buffer_load_dwordx4 v17, s[4:7], s74 offen offset:1024 lds
    ds_read_b64_tr_b16 v[200:201], v39 offset:16384
    buffer_load_dwordx4 v18, s[4:7], s74 offen offset:2048 lds
    ds_read_b64_tr_b16 v[202:203], v39 offset:16896
    buffer_load_dwordx4 v19, s[4:7], s74 offen offset:3072 lds
    ds_read_b64_tr_b16 v[204:205], v39 offset:18432
    ds_read_b64_tr_b16 v[206:207], v39 offset:18944
    ds_read_b128 a[0:3], v20 offset:0
    ds_read_b128 a[4:7], v21 offset:0
    ds_read_b128 a[8:11], v22 offset:0
    ds_read_b128 a[12:15], v23 offset:0
    s_barrier
    ds_read_b64_tr_b16 v[160:161], v34 offset:16384
    ds_read_b64_tr_b16 v[162:163], v34 offset:16896
    ds_read_b64_tr_b16 v[164:165], v35 offset:16384
    ds_read_b64_tr_b16 v[166:167], v35 offset:16896
    ds_read_b64_tr_b16 v[168:169], v36 offset:16384
    ds_read_b64_tr_b16 v[170:171], v36 offset:16896
    ds_read_b64_tr_b16 v[172:173], v37 offset:16384
    ds_read_b64_tr_b16 v[174:175], v37 offset:16896
    ds_read_b64_tr_b16 v[176:177], v34 offset:18432
    ds_read_b64_tr_b16 v[178:179], v34 offset:18944
    ds_read_b64_tr_b16 v[180:181], v35 offset:18432
    ds_read_b64_tr_b16 v[182:183], v35 offset:18944
    s_waitcnt lgkmcnt(15)
    v_dot2c_f32_bf16 v40, s55, v192
    v_dot2c_f32_bf16 v41, s55, v200
    v_dot2c_f32_bf16 v40, s55, v193
    v_dot2c_f32_bf16 v41, s55, v201
    s_add_u32 m0, s54, 24576
    s_add_u32 s75, s75, s58
    buffer_load_dwordx4 v26, s[44:47], s75 offen offset:0 lds
    v_dot2c_f32_bf16 v40, s55, v194
    v_dot2c_f32_bf16 v41, s55, v202
    v_dot2c_f32_bf16 v40, s55, v195
    v_dot2c_f32_bf16 v41, s55, v203
    buffer_load_dwordx4 v27, s[44:47], s75 offen offset:1024 lds
    v_dot2c_f32_bf16 v40, s55, v196
    v_dot2c_f32_bf16 v41, s55, v204
    v_dot2c_f32_bf16 v40, s55, v197
    v_dot2c_f32_bf16 v41, s55, v205
    buffer_load_dwordx4 v28, s[44:47], s75 offen offset:2048 lds
    v_dot2c_f32_bf16 v40, s55, v198
    v_dot2c_f32_bf16 v41, s55, v206
    v_dot2c_f32_bf16 v40, s55, v199
    v_dot2c_f32_bf16 v41, s55, v207
    buffer_load_dwordx4 v29, s[44:47], s75 offen offset:3072 lds
    s_waitcnt vmcnt(8) lgkmcnt(12)
    s_barrier
    s_waitcnt lgkmcnt(8)
    v_mfma_f32_32x32x16_bf16 v[64:79], v[160:163], a[0:3], 0
    ds_read_b64_tr_b16 v[184:185], v36 offset:18432
    ds_read_b64_tr_b16 v[186:187], v36 offset:18944
    s_add_u32 s73, s52, 384
    ds_read_b64_tr_b16 v[192:193], v38 offset:20480
    s_and_b32 s73, s73, 0x3ff
    v_mfma_f32_32x32x16_bf16 v[80:95], v[164:167], a[0:3], 0
    ds_read_b64_tr_b16 v[188:189], v37 offset:18432
    ds_read_b64_tr_b16 v[190:191], v37 offset:18944
    s_or_b32 s74, s73, s56
    ds_read_b64_tr_b16 v[194:195], v38 offset:20992
    s_add_u32 m0, s54, 12288
    s_mul_i32 s75, s73, s59
    buffer_load_dwordx4 v16, s[4:7], s74 offen offset:0 lds
    s_waitcnt lgkmcnt(10)
    v_mfma_f32_32x32x16_bf16 v[96:111], v[168:171], a[0:3], 0
    ds_read_b64_tr_b16 v[160:161], v34 offset:49152
    ds_read_b64_tr_b16 v[162:163], v34 offset:49664
    buffer_load_dwordx4 v17, s[4:7], s74 offen offset:1024 lds
    v_mfma_f32_32x32x16_bf16 v[112:127], v[172:175], a[0:3], 0
    ds_read_b64_tr_b16 v[164:165], v35 offset:49152
    ds_read_b64_tr_b16 v[166:167], v35 offset:49664
    buffer_load_dwordx4 v18, s[4:7], s74 offen offset:2048 lds
    ds_read_b128 a[16:19], v20 offset:4096
    s_waitcnt lgkmcnt(11)
    v_mfma_f32_32x32x16_bf16 v[64:79], v[176:179], a[4:7], v[64:79]
    ds_read_b64_tr_b16 v[168:169], v36 offset:49152
    ds_read_b64_tr_b16 v[170:171], v36 offset:49664
    ds_read_b64_tr_b16 v[196:197], v38 offset:22528
    ds_read_b64_tr_b16 v[198:199], v38 offset:23040
    v_mfma_f32_32x32x16_bf16 v[80:95], v[180:183], a[4:7], v[80:95]
    ds_read_b64_tr_b16 v[172:173], v37 offset:49152
    ds_read_b64_tr_b16 v[174:175], v37 offset:49664
    buffer_load_dwordx4 v19, s[4:7], s74 offen offset:3072 lds
    s_add_u32 m0, s54, 28672
    s_add_u32 s75, s75, s58
    s_waitcnt lgkmcnt(12)
    v_mfma_f32_32x32x16_bf16 v[96:111], v[184:187], a[4:7], v[96:111]
    ds_read_b64_tr_b16 v[176:177], v34 offset:51200
    ds_read_b64_tr_b16 v[178:179], v34 offset:51712
    buffer_load_dwordx4 v26, s[44:47], s75 offen offset:0 lds
    ds_read_b128 a[20:23], v21 offset:4096
    v_mfma_f32_32x32x16_bf16 v[112:127], v[188:191], a[4:7], v[112:127]
    ds_read_b64_tr_b16 v[180:181], v35 offset:51200
    ds_read_b64_tr_b16 v[182:183], v35 offset:51712
    buffer_load_dwordx4 v27, s[44:47], s75 offen offset:1024 lds
    s_waitcnt lgkmcnt(12)
    v_mfma_f32_32x32x16_bf16 v[64:79], v[160:163], a[8:11], v[64:79]
    ds_read_b64_tr_b16 v[184:185], v36 offset:51200
    ds_read_b64_tr_b16 v[186:187], v36 offset:51712
    ds_read_b64_tr_b16 v[200:201], v39 offset:20480
    ds_read_b64_tr_b16 v[202:203], v39 offset:20992
    v_mfma_f32_32x32x16_bf16 v[80:95], v[164:167], a[8:11], v[80:95]
    ds_read_b64_tr_b16 v[188:189], v37 offset:51200
    ds_read_b64_tr_b16 v[190:191], v37 offset:51712
    buffer_load_dwordx4 v28, s[44:47], s75 offen offset:2048 lds
    s_waitcnt lgkmcnt(11)
    v_mfma_f32_32x32x16_bf16 v[96:111], v[168:171], a[8:11], v[96:111]
    ds_read_b64_tr_b16 v[160:161], v34 offset:20480
    ds_read_b64_tr_b16 v[162:163], v34 offset:20992
    buffer_load_dwordx4 v29, s[44:47], s75 offen offset:3072 lds
    ds_read_b128 a[24:27], v22 offset:4096
    v_mfma_f32_32x32x16_bf16 v[112:127], v[172:175], a[8:11], v[112:127]
    ds_read_b64_tr_b16 v[164:165], v35 offset:20480
    ds_read_b64_tr_b16 v[166:167], v35 offset:20992
    buffer_store_dwordx4 v[212:215], v216, s[20:23], s82 offen sc1
    ds_read_b64_tr_b16 v[204:205], v39 offset:22528
    s_waitcnt lgkmcnt(12)
    v_mfma_f32_32x32x16_bf16 v[64:79], v[176:179], a[12:15], v[64:79]
    ds_read_b64_tr_b16 v[168:169], v36 offset:20480
    ds_read_b64_tr_b16 v[170:171], v36 offset:20992
    s_add_u32 m0, s3, 131072
    ds_read_b64_tr_b16 v[206:207], v39 offset:23040
    s_lshl_b32 s80, s50, 11
    v_mfma_f32_32x32x16_bf16 v[80:95], v[180:183], a[12:15], v[80:95]
    ds_read_b64_tr_b16 v[172:173], v37 offset:20480
    ds_read_b64_tr_b16 v[174:175], v37 offset:20992
    buffer_load_dwordx4 v0, s[36:39], s80 offen offset:0 lds
    ds_read_b128 a[28:31], v23 offset:4096
    s_waitcnt lgkmcnt(12)
    v_mfma_f32_32x32x16_bf16 v[96:111], v[184:187], a[12:15], v[96:111]
    ds_read_b64_tr_b16 v[176:177], v34 offset:22528
    ds_read_b64_tr_b16 v[178:179], v34 offset:23040
    buffer_load_dwordx4 v0, s[36:39], s80 offen offset:1024 lds
    s_lshr_b32 s80, s78, 15
    s_lshl_b32 s80, s80, 6
    v_lshrrev_b32 v15, 9, v62
    v_mfma_f32_32x32x16_bf16 v[112:127], v[188:191], a[12:15], v[112:127]
    ds_read_b64_tr_b16 v[180:181], v35 offset:22528
    ds_read_b64_tr_b16 v[182:183], v35 offset:23040
    buffer_load_ushort a248, v15, s[40:43], s80 offen
    s_waitcnt lgkmcnt(7)
    v_dot2c_f32_bf16 v40, s55, v192
    v_dot2c_f32_bf16 v41, s55, v200
    v_dot2c_f32_bf16 v40, s55, v193
    v_dot2c_f32_bf16 v41, s55, v201
    v_dot2c_f32_bf16 v40, s55, v194
    v_dot2c_f32_bf16 v41, s55, v202
    v_dot2c_f32_bf16 v40, s55, v195
    v_dot2c_f32_bf16 v41, s55, v203
    v_dot2c_f32_bf16 v40, s55, v196
    v_dot2c_f32_bf16 v41, s55, v204
    v_dot2c_f32_bf16 v40, s55, v197
    v_dot2c_f32_bf16 v41, s55, v205
    v_dot2c_f32_bf16 v40, s55, v198
    v_dot2c_f32_bf16 v41, s55, v206
    v_dot2c_f32_bf16 v40, s55, v199
    v_dot2c_f32_bf16 v41, s55, v207
    s_waitcnt vmcnt(12) lgkmcnt(4)
    s_barrier
    v_mfma_f32_32x32x16_bf16 v[64:79], v[160:163], a[16:19], v[64:79]
    ds_read_b64_tr_b16 v[184:185], v36 offset:22528
    ds_read_b64_tr_b16 v[186:187], v36 offset:23040
    s_add_u32 s73, s52, 512
    ds_read_b64_tr_b16 v[192:193], v38 offset:24576
    s_lshl_b32 s81, s66, 18
    s_and_b32 s73, s73, 0x3ff
    v_mfma_f32_32x32x16_bf16 v[80:95], v[164:167], a[16:19], v[80:95]
    ds_read_b64_tr_b16 v[188:189], v37 offset:22528
    ds_read_b64_tr_b16 v[190:191], v37 offset:23040
    s_or_b32 s74, s73, s56
    ds_read_b64_tr_b16 v[194:195], v38 offset:25088
    s_and_b32 s71, s48, 1
    s_add_u32 m0, s54, 0
    s_mul_i32 s75, s73, s59
    v_mfma_f32_32x32x16_bf16 v[96:111], v[168:171], a[16:19], v[96:111]
    ds_read_b64_tr_b16 v[160:161], v34 offset:53248
    ds_read_b64_tr_b16 v[162:163], v34 offset:53760
    buffer_load_dwordx4 v16, s[4:7], s74 offen offset:0 lds
    v_mfma_f32_32x32x16_bf16 v[112:127], v[172:175], a[16:19], v[112:127]
    ds_read_b64_tr_b16 v[164:165], v35 offset:53248
    ds_read_b64_tr_b16 v[166:167], v35 offset:53760
    buffer_load_dwordx4 v17, s[4:7], s74 offen offset:1024 lds
    ds_read_b128 a[32:35], v20 offset:8192
    s_lshr_b32 s72, s48, 1
    s_waitcnt lgkmcnt(11)
    v_mfma_f32_32x32x16_bf16 v[64:79], v[176:179], a[20:23], v[64:79]
    ds_read_b64_tr_b16 v[168:169], v36 offset:53248
    ds_read_b64_tr_b16 v[170:171], v36 offset:53760
    ds_read_b64_tr_b16 v[196:197], v38 offset:26624
    s_lshl_b32 s72, s72, 4
    ds_read_b64_tr_b16 v[198:199], v38 offset:27136
    v_mfma_f32_32x32x16_bf16 v[80:95], v[180:183], a[20:23], v[80:95]
    ds_read_b64_tr_b16 v[172:173], v37 offset:53248
    ds_read_b64_tr_b16 v[174:175], v37 offset:53760
    buffer_load_dwordx4 v18, s[4:7], s74 offen offset:2048 lds
    s_waitcnt lgkmcnt(12)
    v_mfma_f32_32x32x16_bf16 v[96:111], v[184:187], a[20:23], v[96:111]
    ds_read_b64_tr_b16 v[176:177], v34 offset:55296
    ds_read_b64_tr_b16 v[178:179], v34 offset:55808
    ds_read_b128 a[36:39], v21 offset:8192
    s_add_u32 s72, s72, s71
    s_lshl_b32 s72, s72, 7
    v_mfma_f32_32x32x16_bf16 v[112:127], v[188:191], a[20:23], v[112:127]
    ds_read_b64_tr_b16 v[180:181], v35 offset:55296
    ds_read_b64_tr_b16 v[182:183], v35 offset:55808
    buffer_load_dwordx4 v19, s[4:7], s74 offen offset:3072 lds
    s_waitcnt lgkmcnt(12)
    v_mfma_f32_32x32x16_bf16 v[64:79], v[160:163], a[24:27], v[64:79]
    ds_read_b64_tr_b16 v[184:185], v36 offset:55296
    ds_read_b64_tr_b16 v[186:187], v36 offset:55808
    ds_read_b64_tr_b16 v[200:201], v39 offset:24576
    s_add_u32 s81, s81, s72
    s_add_u32 m0, s54, 16384
    v_mfma_f32_32x32x16_bf16 v[80:95], v[164:167], a[24:27], v[80:95]
    ds_read_b64_tr_b16 v[188:189], v37 offset:55296
    ds_read_b64_tr_b16 v[190:191], v37 offset:55808
    s_add_u32 s75, s75, s58
    ds_read_b64_tr_b16 v[202:203], v39 offset:25088
    s_lshl_b32 s71, s71, 17
    ds_read_b128 a[40:43], v22 offset:8192
    s_waitcnt lgkmcnt(12)
    v_mfma_f32_32x32x16_bf16 v[96:111], v[168:171], a[24:27], v[96:111]
    ds_read_b64_tr_b16 v[160:161], v34 offset:24576
    ds_read_b64_tr_b16 v[162:163], v34 offset:25088
    buffer_load_dwordx4 v26, s[44:47], s75 offen offset:0 lds
    v_mfma_f32_32x32x16_bf16 v[112:127], v[172:175], a[24:27], v[112:127]
    ds_read_b64_tr_b16 v[164:165], v35 offset:24576
    ds_read_b64_tr_b16 v[166:167], v35 offset:25088
    buffer_load_dwordx4 v27, s[44:47], s75 offen offset:1024 lds
    ds_read_b64_tr_b16 v[204:205], v39 offset:26624
    s_or_b32 s81, s81, s71
    s_waitcnt lgkmcnt(12)
    v_mfma_f32_32x32x16_bf16 v[64:79], v[176:179], a[28:31], v[64:79]
    ds_read_b64_tr_b16 v[168:169], v36 offset:24576
    ds_read_b64_tr_b16 v[170:171], v36 offset:25088
    ds_read_b64_tr_b16 v[206:207], v39 offset:27136
    s_xor_b32 s85, s81, 131072
    ds_read_b128 a[44:47], v23 offset:8192
    v_mfma_f32_32x32x16_bf16 v[80:95], v[180:183], a[28:31], v[80:95]
    ds_read_b64_tr_b16 v[172:173], v37 offset:24576
    ds_read_b64_tr_b16 v[174:175], v37 offset:25088
    buffer_load_dwordx4 v28, s[44:47], s75 offen offset:2048 lds
    s_waitcnt lgkmcnt(13)
    v_mfma_f32_32x32x16_bf16 v[96:111], v[184:187], a[28:31], v[96:111]
    ds_read_b64_tr_b16 v[176:177], v34 offset:26624
    ds_read_b64_tr_b16 v[178:179], v34 offset:27136
    s_mov_b32 s40, 0
    v_mfma_f32_32x32x16_bf16 v[112:127], v[188:191], a[28:31], v[112:127]
    ds_read_b64_tr_b16 v[180:181], v35 offset:26624
    ds_read_b64_tr_b16 v[182:183], v35 offset:27136
    buffer_load_dwordx4 v29, s[44:47], s75 offen offset:3072 lds
    s_waitcnt lgkmcnt(7)
    v_dot2c_f32_bf16 v40, s55, v192
    v_dot2c_f32_bf16 v41, s55, v200
    v_dot2c_f32_bf16 v40, s55, v193
    v_dot2c_f32_bf16 v41, s55, v201
    v_dot2c_f32_bf16 v40, s55, v194
    v_dot2c_f32_bf16 v41, s55, v202
    v_dot2c_f32_bf16 v40, s55, v195
    v_dot2c_f32_bf16 v41, s55, v203
    v_dot2c_f32_bf16 v40, s55, v196
    v_dot2c_f32_bf16 v41, s55, v204
    v_dot2c_f32_bf16 v40, s55, v197
    v_dot2c_f32_bf16 v41, s55, v205
    v_dot2c_f32_bf16 v40, s55, v198
    v_dot2c_f32_bf16 v41, s55, v206
    v_dot2c_f32_bf16 v40, s55, v199
    v_dot2c_f32_bf16 v41, s55, v207
    s_waitcnt vmcnt(12) lgkmcnt(6)
    s_barrier
    v_mfma_f32_32x32x16_bf16 v[64:79], v[160:163], a[32:35], v[64:79]
    ds_read_b64_tr_b16 v[184:185], v36 offset:26624
    ds_read_b64_tr_b16 v[186:187], v36 offset:27136
    s_add_u32 s73, s52, 640
    ds_read_b64_tr_b16 v[192:193], v38 offset:28672
    s_and_b32 s73, s73, 0x3ff
    s_or_b32 s74, s73, s56
    v_mfma_f32_32x32x16_bf16 v[80:95], v[164:167], a[32:35], v[80:95]
    ds_read_b64_tr_b16 v[188:189], v37 offset:26624
    ds_read_b64_tr_b16 v[190:191], v37 offset:27136
    s_add_u32 m0, s54, 4096
    ds_read_b64_tr_b16 v[194:195], v38 offset:29184
    s_lshl_b32 s68, s50, 2
    s_add_u32 s68, s68, s48
    s_lshl_b32 s69, s68, 7
    s_add_u32 s83, s69, 4096
    s_mul_i32 s68, s68, 2176
    s_add_u32 s68, s68, 65536
    s_cmp_eq_u32 s49, 0
    s_cselect_b32 s69, s51, 0
    s_cmp_eq_u32 s69, 1
    s_cselect_b32 s82, s83, 1073741824
    s_cbranch_scc0 Lnozero_1
    v_mov_b32 v8, 0
    v_mov_b32 v9, 0
    v_mov_b32 v10, 0
    v_mov_b32 v11, 0
    v_cmp_gt_u32 vcc, 8, v1
    buffer_store_dwordx4 v[8:11], v0, s[20:23], s68 offen sc1
    buffer_store_dwordx4 v[8:11], v0, s[20:23], s68 offen offset:1024 sc1
    v_cndmask_b32 v3, v60, v0, vcc
    buffer_store_dwordx4 v[8:11], v3, s[20:23], s68 offen offset:2048 sc1
Lnozero_1:
    s_mul_i32 s75, s73, s59
    s_waitcnt lgkmcnt(10)
    v_mfma_f32_32x32x16_bf16 v[96:111], v[168:171], a[32:35], v[96:111]
    ds_read_b64_tr_b16 v[160:161], v34 offset:57344
    ds_read_b64_tr_b16 v[162:163], v34 offset:57856
    buffer_load_dwordx4 v16, s[4:7], s74 offen offset:0 lds
    v_mfma_f32_32x32x16_bf16 v[112:127], v[172:175], a[32:35], v[112:127]
    ds_read_b64_tr_b16 v[164:165], v35 offset:57344
    ds_read_b64_tr_b16 v[166:167], v35 offset:57856
    buffer_load_dwordx4 v17, s[4:7], s74 offen offset:1024 lds
    ds_read_b128 a[48:51], v20 offset:12288
    s_waitcnt lgkmcnt(11)
    v_mfma_f32_32x32x16_bf16 v[64:79], v[176:179], a[36:39], v[64:79]
    ds_read_b64_tr_b16 v[168:169], v36 offset:57344
    ds_read_b64_tr_b16 v[170:171], v36 offset:57856
    ds_read_b64_tr_b16 v[196:197], v38 offset:30720
    ds_read_b64_tr_b16 v[198:199], v38 offset:31232
    v_mfma_f32_32x32x16_bf16 v[80:95], v[180:183], a[36:39], v[80:95]
    ds_read_b64_tr_b16 v[172:173], v37 offset:57344
    ds_read_b64_tr_b16 v[174:175], v37 offset:57856
    buffer_load_dwordx4 v18, s[4:7], s74 offen offset:2048 lds
    s_waitcnt lgkmcnt(12)
    v_mfma_f32_32x32x16_bf16 v[96:111], v[184:187], a[36:39], v[96:111]
    ds_read_b64_tr_b16 v[176:177], v34 offset:59392
    ds_read_b64_tr_b16 v[178:179], v34 offset:59904
    ds_read_b128 a[52:55], v21 offset:12288
    v_mfma_f32_32x32x16_bf16 v[112:127], v[188:191], a[36:39], v[112:127]
    ds_read_b64_tr_b16 v[180:181], v35 offset:59392
    ds_read_b64_tr_b16 v[182:183], v35 offset:59904
    buffer_load_dwordx4 v19, s[4:7], s74 offen offset:3072 lds
    s_waitcnt lgkmcnt(12)
    v_mfma_f32_32x32x16_bf16 v[64:79], v[160:163], a[40:43], v[64:79]
    ds_read_b64_tr_b16 v[184:185], v36 offset:59392
    ds_read_b64_tr_b16 v[186:187], v36 offset:59904
    ds_read_b64_tr_b16 v[200:201], v39 offset:28672
    s_add_u32 m0, s54, 20480
    ds_read_b64_tr_b16 v[202:203], v39 offset:29184
    v_mfma_f32_32x32x16_bf16 v[80:95], v[164:167], a[40:43], v[80:95]
    ds_read_b64_tr_b16 v[188:189], v37 offset:59392
    ds_read_b64_tr_b16 v[190:191], v37 offset:59904
    s_add_u32 s75, s75, s58
    ds_read_b128 a[56:59], v22 offset:12288
    s_waitcnt lgkmcnt(12)
    v_mfma_f32_32x32x16_bf16 v[96:111], v[168:171], a[40:43], v[96:111]
    ds_read_b64_tr_b16 v[160:161], v34 offset:28672
    ds_read_b64_tr_b16 v[162:163], v34 offset:29184
    buffer_load_dwordx4 v26, s[44:47], s75 offen offset:0 lds
    v_mfma_f32_32x32x16_bf16 v[112:127], v[172:175], a[40:43], v[112:127]
    ds_read_b64_tr_b16 v[164:165], v35 offset:28672
    ds_read_b64_tr_b16 v[166:167], v35 offset:29184
    buffer_load_dwordx4 v27, s[44:47], s75 offen offset:1024 lds
    ds_read_b64_tr_b16 v[204:205], v39 offset:30720
    s_waitcnt vmcnt(15)
    ds_read_b64_tr_b16 v[244:245], v59 offset:0
    s_waitcnt lgkmcnt(13)
    v_mfma_f32_32x32x16_bf16 v[64:79], v[176:179], a[44:47], v[64:79]
    ds_read_b64_tr_b16 v[168:169], v36 offset:28672
    ds_read_b64_tr_b16 v[170:171], v36 offset:29184
    ds_read_b64_tr_b16 v[206:207], v39 offset:31232
    ds_read_b64_tr_b16 v[246:247], v59 offset:256
    ds_read_b128 a[60:63], v23 offset:12288
    v_mfma_f32_32x32x16_bf16 v[80:95], v[180:183], a[44:47], v[80:95]
    ds_read_b64_tr_b16 v[172:173], v37 offset:28672
    ds_read_b64_tr_b16 v[174:175], v37 offset:29184
    buffer_load_dwordx4 v28, s[44:47], s75 offen offset:2048 lds
    ds_read_b64_tr_b16 v[248:249], v59 offset:1024
    s_waitcnt lgkmcnt(15)
    v_mfma_f32_32x32x16_bf16 v[96:111], v[184:187], a[44:47], v[96:111]
    ds_read_b64_tr_b16 v[176:177], v34 offset:30720
    ds_read_b64_tr_b16 v[178:179], v34 offset:31232
    ds_read_b64_tr_b16 v[250:251], v59 offset:1280
    v_mfma_f32_32x32x16_bf16 v[112:127], v[188:191], a[44:47], v[112:127]
    ds_read_b64_tr_b16 v[180:181], v35 offset:30720
    ds_read_b64_tr_b16 v[182:183], v35 offset:31232
    buffer_load_dwordx4 v29, s[44:47], s75 offen offset:3072 lds
    s_waitcnt lgkmcnt(10)
    v_dot2c_f32_bf16 v40, s55, v192
    v_dot2c_f32_bf16 v41, s55, v200
    v_dot2c_f32_bf16 v40, s55, v193
    v_dot2c_f32_bf16 v41, s55, v201
    v_dot2c_f32_bf16 v40, s55, v194
    v_dot2c_f32_bf16 v41, s55, v202
    v_dot2c_f32_bf16 v40, s55, v195
    v_dot2c_f32_bf16 v41, s55, v203
    v_dot2c_f32_bf16 v40, s55, v196
    v_dot2c_f32_bf16 v41, s55, v204
    v_dot2c_f32_bf16 v40, s55, v197
    v_dot2c_f32_bf16 v41, s55, v205
    v_dot2c_f32_bf16 v40, s55, v198
    v_dot2c_f32_bf16 v41, s55, v206
    v_dot2c_f32_bf16 v40, s55, v199
    v_dot2c_f32_bf16 v41, s55, v207
    s_waitcnt vmcnt(8) lgkmcnt(8)
    s_barrier
    v_mfma_f32_32x32x16_bf16 v[64:79], v[160:163], a[48:51], v[64:79]
    ds_read_b64_tr_b16 v[184:185], v36 offset:30720
    ds_read_b64_tr_b16 v[186:187], v36 offset:31232
    s_add_u32 s73, s52, 768
    ds_read_b64_tr_b16 v[192:193], v38 offset:16384
    v_bfe_u32 v2, v1, 1, 4
    s_and_b32 s73, s73, 0x3ff
    v_mfma_f32_32x32x16_bf16 v[80:95], v[164:167], a[48:51], v[80:95]
    ds_read_b64_tr_b16 v[188:189], v37 offset:30720
    ds_read_b64_tr_b16 v[190:191], v37 offset:31232
    s_or_b32 s74, s73, s56
    ds_read_b64_tr_b16 v[194:195], v38 offset:16896
    s_add_u32 m0, s54, 8192
    s_mul_i32 s75, s73, s59
    s_waitcnt lgkmcnt(12)
    v_mfma_f32_32x32x16_bf16 v[96:111], v[168:171], a[48:51], v[96:111]
    ds_read_b64_tr_b16 v[160:161], v34 offset:61440
    ds_read_b64_tr_b16 v[162:163], v34 offset:61952
    buffer_load_dwordx4 v16, s[4:7], s74 offen offset:0 lds
    v_mfma_f32_32x32x16_bf16 v[112:127], v[172:175], a[48:51], v[112:127]
    ds_read_b64_tr_b16 v[164:165], v35 offset:61440
    ds_read_b64_tr_b16 v[166:167], v35 offset:61952
    buffer_load_dwordx4 v17, s[4:7], s74 offen offset:1024 lds
    ds_read_b128 a[64:67], v20 offset:0
    v_lshlrev_b32 v2, 7, v2
    s_waitcnt lgkmcnt(11)
    v_mfma_f32_32x32x16_bf16 v[64:79], v[176:179], a[52:55], v[64:79]
    ds_read_b64_tr_b16 v[168:169], v36 offset:61440
    ds_read_b64_tr_b16 v[170:171], v36 offset:61952
    ds_read_b64_tr_b16 v[196:197], v38 offset:18432
    ds_read_b64_tr_b16 v[198:199], v38 offset:18944
    v_mfma_f32_32x32x16_bf16 v[80:95], v[180:183], a[52:55], v[80:95]
    ds_read_b64_tr_b16 v[172:173], v37 offset:61440
    ds_read_b64_tr_b16 v[174:175], v37 offset:61952
    buffer_load_dwordx4 v18, s[4:7], s74 offen offset:2048 lds
    s_waitcnt lgkmcnt(12)
    v_mfma_f32_32x32x16_bf16 v[96:111], v[184:187], a[52:55], v[96:111]
    ds_read_b64_tr_b16 v[176:177], v34 offset:63488
    ds_read_b64_tr_b16 v[178:179], v34 offset:64000
    ds_read_b128 a[68:71], v21 offset:0
    v_and_b32 v3, 1, v1
    v_mfma_f32_32x32x16_bf16 v[112:127], v[188:191], a[52:55], v[112:127]
    ds_read_b64_tr_b16 v[180:181], v35 offset:63488
    ds_read_b64_tr_b16 v[182:183], v35 offset:64000
    buffer_load_dwordx4 v19, s[4:7], s74 offen offset:3072 lds
    s_waitcnt lgkmcnt(12)
    v_mfma_f32_32x32x16_bf16 v[64:79], v[160:163], a[56:59], v[64:79]
    ds_read_b64_tr_b16 v[184:185], v36 offset:63488
    ds_read_b64_tr_b16 v[186:187], v36 offset:64000
    ds_read_b64_tr_b16 v[200:201], v39 offset:16384
    v_lshl_add_u32 v56, v3, 4, v2
    s_add_u32 m0, s54, 24576
    v_mfma_f32_32x32x16_bf16 v[80:95], v[164:167], a[56:59], v[80:95]
    ds_read_b64_tr_b16 v[188:189], v37 offset:63488
    ds_read_b64_tr_b16 v[190:191], v37 offset:64000
    s_add_u32 s75, s75, s58
    ds_read_b64_tr_b16 v[202:203], v39 offset:16896
    ds_read_b128 a[72:75], v22 offset:0
    s_waitcnt lgkmcnt(12)
    v_mfma_f32_32x32x16_bf16 v[96:111], v[168:171], a[56:59], v[96:111]
    ds_read_b64_tr_b16 v[160:161], v34 offset:16384
    ds_read_b64_tr_b16 v[162:163], v34 offset:16896
    buffer_load_dwordx4 v26, s[44:47], s75 offen offset:0 lds
    v_mfma_f32_32x32x16_bf16 v[112:127], v[172:175], a[56:59], v[112:127]
    ds_read_b64_tr_b16 v[164:165], v35 offset:16384
    ds_read_b64_tr_b16 v[166:167], v35 offset:16896
    buffer_load_dwordx4 v27, s[44:47], s75 offen offset:1024 lds
    ds_read_b64_tr_b16 v[204:205], v39 offset:18432
    s_lshl_b32 s79, s63, 11
    s_waitcnt lgkmcnt(12)
    v_mfma_f32_32x32x16_bf16 v[64:79], v[176:179], a[60:63], v[64:79]
    ds_read_b64_tr_b16 v[168:169], v36 offset:16384
    ds_read_b64_tr_b16 v[170:171], v36 offset:16896
    ds_read_b64_tr_b16 v[206:207], v39 offset:18944
    s_add_u32 s79, s79, 13107200
    ds_read_b128 a[76:79], v23 offset:0
    v_mfma_f32_32x32x16_bf16 v[80:95], v[180:183], a[60:63], v[80:95]
    ds_read_b64_tr_b16 v[172:173], v37 offset:16384
    ds_read_b64_tr_b16 v[174:175], v37 offset:16896
    buffer_load_dwordx4 v28, s[44:47], s75 offen offset:2048 lds
    s_waitcnt lgkmcnt(13)
    v_mfma_f32_32x32x16_bf16 v[96:111], v[184:187], a[60:63], v[96:111]
    ds_read_b64_tr_b16 v[176:177], v34 offset:18432
    ds_read_b64_tr_b16 v[178:179], v34 offset:18944
    v_mfma_f32_32x32x16_bf16 v[112:127], v[188:191], a[60:63], v[112:127]
    ds_read_b64_tr_b16 v[180:181], v35 offset:18432
    ds_read_b64_tr_b16 v[182:183], v35 offset:18944
    buffer_load_dwordx4 v29, s[44:47], s75 offen offset:3072 lds
    s_waitcnt lgkmcnt(7)
    v_dot2c_f32_bf16 v40, s55, v192
    v_dot2c_f32_bf16 v41, s55, v200
    v_dot2c_f32_bf16 v40, s55, v193
    v_dot2c_f32_bf16 v41, s55, v201
    v_dot2c_f32_bf16 v40, s55, v194
    v_dot2c_f32_bf16 v41, s55, v202
    v_dot2c_f32_bf16 v40, s55, v195
    v_dot2c_f32_bf16 v41, s55, v203
    v_dot2c_f32_bf16 v40, s55, v196
    v_dot2c_f32_bf16 v41, s55, v204
    v_dot2c_f32_bf16 v40, s55, v197
    v_dot2c_f32_bf16 v41, s55, v205
    v_dot2c_f32_bf16 v40, s55, v198
    v_dot2c_f32_bf16 v41, s55, v206
    v_dot2c_f32_bf16 v40, s55, v199
    v_dot2c_f32_bf16 v41, s55, v207
    s_waitcnt vmcnt(8) lgkmcnt(6)
    s_barrier
    v_mfma_f32_32x32x16_bf16 v[64:79], v[160:163], a[64:67], v[64:79]
    ds_read_b64_tr_b16 v[184:185], v36 offset:18432
    ds_read_b64_tr_b16 v[186:187], v36 offset:18944
    s_add_u32 s73, s52, 896
    ds_read_b64_tr_b16 v[192:193], v38 offset:20480
    s_and_b32 s73, s73, 0x3ff
    v_mfma_f32_32x32x16_bf16 v[80:95], v[164:167], a[64:67], v[80:95]
    ds_read_b64_tr_b16 v[188:189], v37 offset:18432
    ds_read_b64_tr_b16 v[190:191], v37 offset:18944
    buffer_load_dwordx4 v[240:243], v56, s[20:23], s79 offen sc1
    s_or_b32 s74, s73, s56
    s_add_u32 m0, s54, 12288
    s_mul_i32 s75, s73, s59
    s_waitcnt lgkmcnt(9)
    v_mfma_f32_32x32x16_bf16 v[96:111], v[168:171], a[64:67], v[96:111]
    ds_read_b64_tr_b16 v[160:161], v34 offset:49152
    ds_read_b64_tr_b16 v[162:163], v34 offset:49664
    buffer_load_dwordx4 v16, s[4:7], s74 offen offset:0 lds
    ds_read_b64_tr_b16 v[194:195], v38 offset:20992
    v_mfma_f32_32x32x16_bf16 v[112:127], v[172:175], a[64:67], v[112:127]
    ds_read_b64_tr_b16 v[164:165], v35 offset:49152
    ds_read_b64_tr_b16 v[166:167], v35 offset:49664
    buffer_load_dwordx4 v17, s[4:7], s74 offen offset:1024 lds
    ds_read_b128 a[80:83], v20 offset:4096
    s_waitcnt lgkmcnt(11)
    v_mfma_f32_32x32x16_bf16 v[64:79], v[176:179], a[68:71], v[64:79]
    ds_read_b64_tr_b16 v[168:169], v36 offset:49152
    ds_read_b64_tr_b16 v[170:171], v36 offset:49664
    ds_read_b64_tr_b16 v[196:197], v38 offset:22528
    ds_read_b64_tr_b16 v[198:199], v38 offset:23040
    v_mfma_f32_32x32x16_bf16 v[80:95], v[180:183], a[68:71], v[80:95]
    ds_read_b64_tr_b16 v[172:173], v37 offset:49152
    ds_read_b64_tr_b16 v[174:175], v37 offset:49664
    buffer_load_dwordx4 v18, s[4:7], s74 offen offset:2048 lds
    s_waitcnt lgkmcnt(12)
    v_mfma_f32_32x32x16_bf16 v[96:111], v[184:187], a[68:71], v[96:111]
    ds_read_b64_tr_b16 v[176:177], v34 offset:51200
    ds_read_b64_tr_b16 v[178:179], v34 offset:51712
    ds_read_b128 a[84:87], v21 offset:4096
    v_mfma_f32_32x32x16_bf16 v[112:127], v[188:191], a[68:71], v[112:127]
    ds_read_b64_tr_b16 v[180:181], v35 offset:51200
    ds_read_b64_tr_b16 v[182:183], v35 offset:51712
    buffer_load_dwordx4 v19, s[4:7], s74 offen offset:3072 lds
    s_waitcnt lgkmcnt(12)
    v_mfma_f32_32x32x16_bf16 v[64:79], v[160:163], a[72:75], v[64:79]
    ds_read_b64_tr_b16 v[184:185], v36 offset:51200
    ds_read_b64_tr_b16 v[186:187], v36 offset:51712
    s_add_u32 m0, s54, 28672
    ds_read_b64_tr_b16 v[200:201], v39 offset:20480
    s_add_u32 s75, s75, s58
    v_mfma_f32_32x32x16_bf16 v[80:95], v[164:167], a[72:75], v[80:95]
    ds_read_b64_tr_b16 v[188:189], v37 offset:51200
    ds_read_b64_tr_b16 v[190:191], v37 offset:51712
    buffer_load_dwordx4 v26, s[44:47], s75 offen offset:0 lds
    ds_read_b64_tr_b16 v[202:203], v39 offset:20992
    s_waitcnt lgkmcnt(11)
    v_mfma_f32_32x32x16_bf16 v[96:111], v[168:171], a[72:75], v[96:111]
    ds_read_b64_tr_b16 v[160:161], v34 offset:20480
    ds_read_b64_tr_b16 v[162:163], v34 offset:20992
    ds_read_b128 a[88:91], v22 offset:4096
    ds_read_b64_tr_b16 v[204:205], v39 offset:22528
    v_mfma_f32_32x32x16_bf16 v[112:127], v[172:175], a[72:75], v[112:127]
    ds_read_b64_tr_b16 v[164:165], v35 offset:20480
    ds_read_b64_tr_b16 v[166:167], v35 offset:20992
    buffer_load_dwordx4 v27, s[44:47], s75 offen offset:1024 lds
    s_waitcnt lgkmcnt(12)
    v_mfma_f32_32x32x16_bf16 v[64:79], v[176:179], a[76:79], v[64:79]
    ds_read_b64_tr_b16 v[168:169], v36 offset:20480
    ds_read_b64_tr_b16 v[170:171], v36 offset:20992
    ds_read_b64_tr_b16 v[206:207], v39 offset:23040
    ds_read_b128 a[92:95], v23 offset:4096
    v_mfma_f32_32x32x16_bf16 v[80:95], v[180:183], a[76:79], v[80:95]
    ds_read_b64_tr_b16 v[172:173], v37 offset:20480
    ds_read_b64_tr_b16 v[174:175], v37 offset:20992
    buffer_load_dwordx4 v28, s[44:47], s75 offen offset:2048 lds
    s_waitcnt lgkmcnt(13)
    v_mfma_f32_32x32x16_bf16 v[96:111], v[184:187], a[76:79], v[96:111]
    ds_read_b64_tr_b16 v[176:177], v34 offset:22528
    ds_read_b64_tr_b16 v[178:179], v34 offset:23040
    v_mfma_f32_32x32x16_bf16 v[112:127], v[188:191], a[76:79], v[112:127]
    ds_read_b64_tr_b16 v[180:181], v35 offset:22528
    ds_read_b64_tr_b16 v[182:183], v35 offset:23040
    buffer_load_dwordx4 v29, s[44:47], s75 offen offset:3072 lds
    s_waitcnt lgkmcnt(7)
    v_dot2c_f32_bf16 v40, s55, v192
    v_dot2c_f32_bf16 v41, s55, v200
    v_dot2c_f32_bf16 v40, s55, v193
    v_dot2c_f32_bf16 v41, s55, v201
    v_dot2c_f32_bf16 v40, s55, v194
    v_dot2c_f32_bf16 v41, s55, v202
    v_dot2c_f32_bf16 v40, s55, v195
    v_dot2c_f32_bf16 v41, s55, v203
    v_dot2c_f32_bf16 v40, s55, v196
    v_dot2c_f32_bf16 v41, s55, v204
    v_dot2c_f32_bf16 v40, s55, v197
    v_dot2c_f32_bf16 v41, s55, v205
    v_dot2c_f32_bf16 v40, s55, v198
    v_dot2c_f32_bf16 v41, s55, v206
    v_dot2c_f32_bf16 v40, s55, v199
    v_dot2c_f32_bf16 v41, s55, v207
    s_waitcnt vmcnt(9) lgkmcnt(6)
    s_barrier
    v_mfma_f32_32x32x16_bf16 v[64:79], v[160:163], a[80:83], v[64:79]
    ds_read_b64_tr_b16 v[184:185], v36 offset:22528
    ds_read_b64_tr_b16 v[186:187], v36 offset:23040
    v_lshrrev_b32 v4, 3, v1
    ds_read_b64_tr_b16 v[192:193], v38 offset:24576
    v_lshrrev_b32 v5, 4, v1
    v_and_b32 v6, 7, v1
    v_mfma_f32_32x32x16_bf16 v[80:95], v[164:167], a[80:83], v[80:95]
    ds_read_b64_tr_b16 v[188:189], v37 offset:22528
    ds_read_b64_tr_b16 v[190:191], v37 offset:23040
    v_xor_b32 v5, v6, v5
    ds_read_b64_tr_b16 v[194:195], v38 offset:25088
    v_lshlrev_b32 v5, 4, v5
    v_lshl_add_u32 v16, v4, 12, v5
    v_xor_b32 v6, 64, v16
    v_add_u32 v17, 31744, v6
    v_add_u32 v18, 63488, v16
    v_add_u32 v19, 95232, v6
    s_add_u32 s74, s52, 0
    s_and_b32 s74, s74, 0x3ff
    s_mul_i32 s74, s74, s12
    s_add_u32 m0, s3, 131072
    s_add_u32 s74, s74, s57
    s_waitcnt lgkmcnt(10)
    v_mfma_f32_32x32x16_bf16 v[96:111], v[168:171], a[80:83], v[96:111]
    ds_read_b64_tr_b16 v[160:161], v34 offset:53248
    ds_read_b64_tr_b16 v[162:163], v34 offset:53760
    buffer_load_dwordx4 v24, s[8:11], s74 offen offset:0 lds
    v_mfma_f32_32x32x16_bf16 v[112:127], v[172:175], a[80:83], v[112:127]
    ds_read_b64_tr_b16 v[164:165], v35 offset:53248
    ds_read_b64_tr_b16 v[166:167], v35 offset:53760
    buffer_load_dwordx4 v25, s[8:11], s74 offen offset:1024 lds
    ds_read_b128 a[96:99], v20 offset:8192
    s_waitcnt lgkmcnt(11)
    v_mfma_f32_32x32x16_bf16 v[64:79], v[176:179], a[84:87], v[64:79]
    ds_read_b64_tr_b16 v[168:169], v36 offset:53248
    ds_read_b64_tr_b16 v[170:171], v36 offset:53760
    ds_read_b64_tr_b16 v[196:197], v38 offset:26624
    s_add_u32 m0, s54, 0
    ds_read_b64_tr_b16 v[198:199], v38 offset:27136
    v_mfma_f32_32x32x16_bf16 v[80:95], v[180:183], a[84:87], v[80:95]
    ds_read_b64_tr_b16 v[172:173], v37 offset:53248
    ds_read_b64_tr_b16 v[174:175], v37 offset:53760
    s_add_u32 s75, s81, 0
    ds_read_b128 a[100:103], v21 offset:8192
    s_waitcnt lgkmcnt(13)
    v_mfma_f32_32x32x16_bf16 v[96:111], v[184:187], a[84:87], v[96:111]
    ds_read_b64_tr_b16 v[176:177], v34 offset:55296
    ds_read_b64_tr_b16 v[178:179], v34 offset:55808
    buffer_load_dwordx4 v16, s[16:19], s75 offen offset:0 lds
    v_mfma_f32_32x32x16_bf16 v[112:127], v[188:191], a[84:87], v[112:127]
    ds_read_b64_tr_b16 v[180:181], v35 offset:55296
    ds_read_b64_tr_b16 v[182:183], v35 offset:55808
    buffer_load_dwordx4 v17, s[16:19], s75 offen offset:1024 lds
    s_waitcnt lgkmcnt(12)
    v_mfma_f32_32x32x16_bf16 v[64:79], v[160:163], a[88:91], v[64:79]
    ds_read_b64_tr_b16 v[184:185], v36 offset:55296
    ds_read_b64_tr_b16 v[186:187], v36 offset:55808
    ds_read_b64_tr_b16 v[200:201], v39 offset:24576
    ds_read_b64_tr_b16 v[202:203], v39 offset:25088
    v_mfma_f32_32x32x16_bf16 v[80:95], v[164:167], a[88:91], v[80:95]
    ds_read_b64_tr_b16 v[188:189], v37 offset:55296
    ds_read_b64_tr_b16 v[190:191], v37 offset:55808
    buffer_load_dwordx4 v18, s[16:19], s75 offen offset:2048 lds
    s_waitcnt lgkmcnt(11)
    v_mfma_f32_32x32x16_bf16 v[96:111], v[168:171], a[88:91], v[96:111]
    ds_read_b64_tr_b16 v[160:161], v34 offset:24576
    ds_read_b64_tr_b16 v[162:163], v34 offset:25088
    ds_read_b128 a[104:107], v22 offset:8192
    ds_read_b64_tr_b16 v[204:205], v39 offset:26624
    v_mfma_f32_32x32x16_bf16 v[112:127], v[172:175], a[88:91], v[112:127]
    ds_read_b64_tr_b16 v[164:165], v35 offset:24576
    ds_read_b64_tr_b16 v[166:167], v35 offset:25088
    buffer_load_dwordx4 v19, s[16:19], s75 offen offset:3072 lds
    s_waitcnt lgkmcnt(12)
    v_mfma_f32_32x32x16_bf16 v[64:79], v[176:179], a[92:95], v[64:79]
    ds_read_b64_tr_b16 v[168:169], v36 offset:24576
    ds_read_b64_tr_b16 v[170:171], v36 offset:25088
    ds_read_b64_tr_b16 v[206:207], v39 offset:27136
    ds_read_b128 a[108:111], v23 offset:8192
    v_mfma_f32_32x32x16_bf16 v[80:95], v[180:183], a[92:95], v[80:95]
    ds_read_b64_tr_b16 v[172:173], v37 offset:24576
    ds_read_b64_tr_b16 v[174:175], v37 offset:25088
    s_waitcnt lgkmcnt(12)
    v_mfma_f32_32x32x16_bf16 v[96:111], v[184:187], a[92:95], v[96:111]
    ds_read_b64_tr_b16 v[176:177], v34 offset:26624
    ds_read_b64_tr_b16 v[178:179], v34 offset:27136
    v_mfma_f32_32x32x16_bf16 v[112:127], v[188:191], a[92:95], v[112:127]
    ds_read_b64_tr_b16 v[180:181], v35 offset:26624
    ds_read_b64_tr_b16 v[182:183], v35 offset:27136
    s_waitcnt lgkmcnt(7)
    v_dot2c_f32_bf16 v40, s55, v192
    v_dot2c_f32_bf16 v41, s55, v200
    v_dot2c_f32_bf16 v40, s55, v193
    v_dot2c_f32_bf16 v41, s55, v201
    v_dot2c_f32_bf16 v40, s55, v194
    v_dot2c_f32_bf16 v41, s55, v202
    v_dot2c_f32_bf16 v40, s55, v195
    v_dot2c_f32_bf16 v41, s55, v203
    v_dot2c_f32_bf16 v40, s55, v196
    v_dot2c_f32_bf16 v41, s55, v204
    v_dot2c_f32_bf16 v40, s55, v197
    v_dot2c_f32_bf16 v41, s55, v205
    v_dot2c_f32_bf16 v40, s55, v198
    v_dot2c_f32_bf16 v41, s55, v206
    v_dot2c_f32_bf16 v40, s55, v199
    v_dot2c_f32_bf16 v41, s55, v207
    s_waitcnt vmcnt(6) lgkmcnt(6)
    s_barrier
    v_mfma_f32_32x32x16_bf16 v[64:79], v[160:163], a[96:99], v[64:79]
    ds_read_b64_tr_b16 v[184:185], v36 offset:26624
    ds_read_b64_tr_b16 v[186:187], v36 offset:27136
    s_add_u32 s74, s52, 128
    ds_read_b64_tr_b16 v[192:193], v38 offset:28672
    s_and_b32 s74, s74, 0x3ff
    s_mul_i32 s74, s74, s12
    v_mfma_f32_32x32x16_bf16 v[80:95], v[164:167], a[96:99], v[80:95]
    ds_read_b64_tr_b16 v[188:189], v37 offset:26624
    ds_read_b64_tr_b16 v[190:191], v37 offset:27136
    s_add_u32 m0, s3, 139264
    ds_read_b64_tr_b16 v[194:195], v38 offset:29184
    v_cmp_ne_u32 vcc, s53, v243
    s_nop 1
    s_and_b32 s68, vcc_lo, -1
    s_cbranch_scc1 Ls_2
Lb_3:
    v_mov_b32 v14, s53
    buffer_store_dword v14, v61, s[20:23], s82 offen sc1
    s_add_u32 s74, s74, s57
    s_waitcnt lgkmcnt(10)
    v_mfma_f32_32x32x16_bf16 v[96:111], v[168:171], a[96:99], v[96:111]
    ds_read_b64_tr_b16 v[160:161], v34 offset:57344
    ds_read_b64_tr_b16 v[162:163], v34 offset:57856
    buffer_load_dwordx4 v24, s[8:11], s74 offen offset:0 lds
    v_mfma_f32_32x32x16_bf16 v[112:127], v[172:175], a[96:99], v[112:127]
    ds_read_b64_tr_b16 v[164:165], v35 offset:57344
    ds_read_b64_tr_b16 v[166:167], v35 offset:57856
    buffer_load_dwordx4 v25, s[8:11], s74 offen offset:1024 lds
    ds_read_b128 a[112:115], v20 offset:12288
    s_waitcnt lgkmcnt(11)
    v_mfma_f32_32x32x16_bf16 v[64:79], v[176:179], a[100:103], v[64:79]
    ds_read_b64_tr_b16 v[168:169], v36 offset:57344
    ds_read_b64_tr_b16 v[170:171], v36 offset:57856
    ds_read_b64_tr_b16 v[196:197], v38 offset:30720
    s_add_u32 m0, s54, 4096
    ds_read_b64_tr_b16 v[198:199], v38 offset:31232
    v_mfma_f32_32x32x16_bf16 v[80:95], v[180:183], a[100:103], v[80:95]
    ds_read_b64_tr_b16 v[172:173], v37 offset:57344
    ds_read_b64_tr_b16 v[174:175], v37 offset:57856
    s_add_u32 s75, s85, 0
    ds_read_b128 a[116:119], v21 offset:12288
    s_waitcnt lgkmcnt(13)
    v_mfma_f32_32x32x16_bf16 v[96:111], v[184:187], a[100:103], v[96:111]
    ds_read_b64_tr_b16 v[176:177], v34 offset:59392
    ds_read_b64_tr_b16 v[178:179], v34 offset:59904
    buffer_load_dwordx4 v16, s[16:19], s75 offen offset:0 lds
    v_mfma_f32_32x32x16_bf16 v[112:127], v[188:191], a[100:103], v[112:127]
    ds_read_b64_tr_b16 v[180:181], v35 offset:59392
    ds_read_b64_tr_b16 v[182:183], v35 offset:59904
    buffer_load_dwordx4 v17, s[16:19], s75 offen offset:1024 lds
    v_mov_b32 v50, v241
    v_mov_b32 v48, v242
    s_waitcnt lgkmcnt(12)
    v_mfma_f32_32x32x16_bf16 v[64:79], v[160:163], a[104:107], v[64:79]
    ds_read_b64_tr_b16 v[184:185], v36 offset:59392
    ds_read_b64_tr_b16 v[186:187], v36 offset:59904
    ds_read_b64_tr_b16 v[200:201], v39 offset:28672
    v_mul_f32 v44, 0xc0135761, v241
    ds_read_b64_tr_b16 v[202:203], v39 offset:29184
    v_mfma_f32_32x32x16_bf16 v[80:95], v[164:167], a[104:107], v[80:95]
    ds_read_b64_tr_b16 v[188:189], v37 offset:59392
    ds_read_b64_tr_b16 v[190:191], v37 offset:59904
    buffer_load_dwordx4 v18, s[16:19], s75 offen offset:2048 lds
    v_mul_f32 v6, v241, v241
    v_mul_f32 v6, 0x3d372713, v6
    s_waitcnt lgkmcnt(11)
    v_mfma_f32_32x32x16_bf16 v[96:111], v[168:171], a[104:107], v[96:111]
    ds_read_b64_tr_b16 v[160:161], v34 offset:28672
    ds_read_b64_tr_b16 v[162:163], v34 offset:29184
    ds_read_b128 a[120:123], v22 offset:12288
    v_mul_f32 v46, v6, v44
    ds_read_b64_tr_b16 v[204:205], v39 offset:30720
    v_mfma_f32_32x32x16_bf16 v[112:127], v[172:175], a[104:107], v[112:127]
    ds_read_b64_tr_b16 v[164:165], v35 offset:28672
    ds_read_b64_tr_b16 v[166:167], v35 offset:29184
    buffer_load_dwordx4 v19, s[16:19], s75 offen offset:3072 lds
    v_mul_f32 v58, 0x3fb8aa3b, v241
    v_cmp_eq_u32 vcc, 0, v57
    s_waitcnt lgkmcnt(12)
    v_mfma_f32_32x32x16_bf16 v[64:79], v[176:179], a[108:111], v[64:79]
    ds_read_b64_tr_b16 v[168:169], v36 offset:28672
    ds_read_b64_tr_b16 v[170:171], v36 offset:29184
    ds_read_b64_tr_b16 v[206:207], v39 offset:31232
    v_cvt_pk_bf16_f32 v6, v240, v240
    ds_read_b128 a[124:127], v23 offset:12288
    v_and_b32 v7, 0xffff0000, v6
    v_mfma_f32_32x32x16_bf16 v[80:95], v[180:183], a[108:111], v[80:95]
    ds_read_b64_tr_b16 v[172:173], v37 offset:28672
    ds_read_b64_tr_b16 v[174:175], v37 offset:29184
    v_sub_f32 v7, v240, v7
    v_cvt_pk_bf16_f32 v6, v240, v7
    v_cndmask_b32 v52, 0, v6, vcc
    s_waitcnt lgkmcnt(12)
    v_mfma_f32_32x32x16_bf16 v[96:111], v[184:187], a[108:111], v[96:111]
    ds_read_b64_tr_b16 v[176:177], v34 offset:30720
    ds_read_b64_tr_b16 v[178:179], v34 offset:31232
    v_cndmask_b32 v53, 0, v6, vcc
    v_mfma_f32_32x32x16_bf16 v[112:127], v[188:191], a[108:111], v[112:127]
    ds_read_b64_tr_b16 v[180:181], v35 offset:30720
    ds_read_b64_tr_b16 v[182:183], v35 offset:31232
    s_waitcnt lgkmcnt(7)
    v_dot2c_f32_bf16 v40, s55, v192
    v_dot2c_f32_bf16 v41, s55, v200
    v_dot2c_f32_bf16 v40, s55, v193
    v_dot2c_f32_bf16 v41, s55, v201
    v_dot2c_f32_bf16 v40, s55, v194
    v_dot2c_f32_bf16 v41, s55, v202
    v_dot2c_f32_bf16 v40, s55, v195
    v_dot2c_f32_bf16 v41, s55, v203
    v_dot2c_f32_bf16 v40, s55, v196
    v_dot2c_f32_bf16 v41, s55, v204
    v_dot2c_f32_bf16 v40, s55, v197
    v_dot2c_f32_bf16 v41, s55, v205
    v_dot2c_f32_bf16 v40, s55, v198
    v_dot2c_f32_bf16 v41, s55, v206
    v_dot2c_f32_bf16 v40, s55, v199
    v_dot2c_f32_bf16 v41, s55, v207
    s_nop 2
    ds_write_b32 v255, v40
    ds_write_b32 v255, v41 offset:512
    s_waitcnt lgkmcnt(0)
    s_barrier
    v_mfma_f32_32x32x16_bf16 v[64:79], v[160:163], a[112:115], v[64:79]
    ds_read_b64_tr_b16 v[184:185], v36 offset:30720
    ds_read_b64_tr_b16 v[186:187], v36 offset:31232
    s_add_u32 s74, s52, 256
    ds_read_b128 v[208:211], v254 offset:0
    s_and_b32 s74, s74, 0x3ff
    ds_read_b128 v[216:219], v254 offset:512
    v_mfma_f32_32x32x16_bf16 v[80:95], v[164:167], a[112:115], v[80:95]
    ds_read_b64_tr_b16 v[188:189], v37 offset:30720
    ds_read_b64_tr_b16 v[190:191], v37 offset:31232
    s_mul_i32 s74, s74, s12
    ds_read_b128 v[224:227], v254 offset:1024
    ds_read_b128 v[232:235], v254 offset:1536
    s_add_u32 m0, s3, 147456
    v_mov_b32 v40, 0
    s_add_u32 s74, s74, s57
    v_mfma_f32_32x32x16_bf16 v[96:111], v[168:171], a[112:115], v[96:111]
    ds_read_b64_tr_b16 v[160:161], v34 offset:61440
    ds_read_b64_tr_b16 v[162:163], v34 offset:61952
    buffer_load_dwordx4 v24, s[8:11], s74 offen offset:0 lds
    v_mov_b32 v41, 0
    v_and_b32 v5, 4, v1
    v_cmp_eq_u32 s[76:77], 0, v5
    v_accvgpr_read_b32 v26, a249
    v_mfma_f32_32x32x16_bf16 v[112:127], v[172:175], a[112:115], v[112:127]
    ds_read_b64_tr_b16 v[164:165], v35 offset:61440
    ds_read_b64_tr_b16 v[166:167], v35 offset:61952
    buffer_load_dwordx4 v25, s[8:11], s74 offen offset:1024 lds
    v_accvgpr_read_b32 v27, a250
    v_cndmask_b32 v192, 0, v244, s[76:77]
    v_cndmask_b32 v196, v244, 0, s[76:77]
    v_cndmask_b32 v193, 0, v245, s[76:77]
    v_mfma_f32_32x32x16_bf16 v[64:79], v[176:179], a[116:119], v[64:79]
    ds_read_b64_tr_b16 v[168:169], v36 offset:61440
    ds_read_b64_tr_b16 v[170:171], v36 offset:61952
    v_cndmask_b32 v197, v245, 0, s[76:77]
    s_add_u32 m0, s54, 16384
    v_cndmask_b32 v194, 0, v246, s[76:77]
    s_add_u32 s75, s81, 256
    v_cndmask_b32 v198, v246, 0, s[76:77]
    v_cndmask_b32 v195, 0, v247, s[76:77]
    v_mfma_f32_32x32x16_bf16 v[80:95], v[180:183], a[116:119], v[80:95]
    ds_read_b64_tr_b16 v[172:173], v37 offset:61440
    ds_read_b64_tr_b16 v[174:175], v37 offset:61952
    buffer_load_dwordx4 v16, s[16:19], s75 offen offset:0 lds
    v_cndmask_b32 v199, v247, 0, s[76:77]
    v_cndmask_b32 v200, 0, v248, s[76:77]
    v_cndmask_b32 v204, v248, 0, s[76:77]
    v_cndmask_b32 v201, 0, v249, s[76:77]
    s_waitcnt lgkmcnt(10)
    v_mfma_f32_32x32x16_bf16 v[96:111], v[184:187], a[116:119], v[96:111]
    ds_read_b64_tr_b16 v[176:177], v34 offset:63488
    ds_read_b64_tr_b16 v[178:179], v34 offset:64000
    v_cndmask_b32 v205, v249, 0, s[76:77]
    v_cndmask_b32 v202, 0, v250, s[76:77]
    v_cndmask_b32 v206, v250, 0, s[76:77]
    v_cndmask_b32 v203, 0, v251, s[76:77]
    v_cndmask_b32 v207, v251, 0, s[76:77]
    v_mfma_f32_32x32x16_bf16 v[112:127], v[188:191], a[116:119], v[112:127]
    ds_read_b64_tr_b16 v[180:181], v35 offset:63488
    ds_read_b64_tr_b16 v[182:183], v35 offset:64000
    buffer_load_dwordx4 v17, s[16:19], s75 offen offset:1024 lds
    s_waitcnt lgkmcnt(12)
    v_add_f32 v208, v208, v209
    v_add_f32 v210, v210, v211
    v_add_f32 v208, v208, v210
    s_waitcnt lgkmcnt(8)
    v_mfma_f32_32x32x16_bf16 v[64:79], v[160:163], a[120:123], v[64:79]
    ds_read_b64_tr_b16 v[184:185], v36 offset:63488
    ds_read_b64_tr_b16 v[186:187], v36 offset:64000
    v_cvt_pk_bf16_f32 v212, v208, v208
    v_and_b32 v213, 0xffff0000, v212
    v_sub_f32 v213, v208, v213
    v_cvt_pk_bf16_f32 v213, v213, v213
    v_mfma_f32_32x32x16_bf16 v[80:95], v[164:167], a[120:123], v[80:95]
    ds_read_b64_tr_b16 v[188:189], v37 offset:63488
    ds_read_b64_tr_b16 v[190:191], v37 offset:64000
    buffer_load_dwordx4 v18, s[16:19], s75 offen offset:2048 lds
    v_mov_b32 v214, 0
    v_mov_b32 v215, 0
    v_add_f32 v216, v216, v217
    v_add_f32 v218, v218, v219
    s_waitcnt lgkmcnt(8)
    v_mfma_f32_32x32x16_bf16 v[96:111], v[168:171], a[120:123], v[96:111]
    v_add_f32 v216, v216, v218
    v_cvt_pk_bf16_f32 v220, v216, v216
    v_and_b32 v221, 0xffff0000, v220
    v_sub_f32 v221, v216, v221
    v_cvt_pk_bf16_f32 v221, v221, v221
    v_mfma_f32_32x32x16_bf16 v[112:127], v[172:175], a[120:123], v[112:127]
    buffer_load_dwordx4 v19, s[16:19], s75 offen offset:3072 lds
    v_mov_b32 v222, 0
    v_mov_b32 v223, 0
    v_add_f32 v224, v224, v225
    v_add_f32 v226, v226, v227
    s_waitcnt lgkmcnt(4)
    v_mfma_f32_32x32x16_bf16 v[64:79], v[176:179], a[124:127], v[64:79]
    v_add_f32 v224, v224, v226
    v_cvt_pk_bf16_f32 v228, v224, v224
    v_and_b32 v229, 0xffff0000, v228
    v_sub_f32 v229, v224, v229
    v_cvt_pk_bf16_f32 v229, v229, v229
    v_mfma_f32_32x32x16_bf16 v[80:95], v[180:183], a[124:127], v[80:95]
    v_mov_b32 v230, 0
    v_mov_b32 v231, 0
    v_add_f32 v232, v232, v233
    v_add_f32 v234, v234, v235
    v_add_f32 v232, v232, v234
    v_cvt_pk_bf16_f32 v236, v232, v232
    s_waitcnt lgkmcnt(0)
    v_mfma_f32_32x32x16_bf16 v[96:111], v[184:187], a[124:127], v[96:111]
    v_and_b32 v237, 0xffff0000, v236
    v_sub_f32 v237, v232, v237
    v_cvt_pk_bf16_f32 v237, v237, v237
    v_mov_b32 v238, 0
    v_mov_b32 v239, 0
    v_mfma_f32_32x32x16_bf16 v[112:127], v[188:191], a[124:127], v[112:127]
    s_nop 0
    v_mfma_f32_32x32x16_bf16 v[96:111], v[228:231], v[52:55], v[96:111]
    v_mfma_f32_32x32x16_bf16 v[112:127], v[236:239], v[52:55], v[112:127]
    v_mfma_f32_32x32x16_bf16 v[64:79], v[212:215], v[52:55], v[64:79]
    v_mfma_f32_32x32x16_bf16 v[80:95], v[220:223], v[52:55], v[80:95]
    s_barrier
    s_lshl_b32 s68, s49, 15
    s_lshl_b32 s69, s48, 9
    s_add_u32 s68, s68, s69
    s_add_u32 s68, s68, 262144
    s_lshl_b32 s69, s60, 11
    s_add_u32 s70, s68, s69
    s_cmp_eq_u32 s61, 0
    s_cselect_b32 s82, 1073741824, s68
    v_cvt_pk_bf16_f32 v160, v96, v97
    v_cvt_pk_bf16_f32 v161, v98, v99
    v_cvt_pk_bf16_f32 v162, v100, v101
    v_cvt_pk_bf16_f32 v163, v102, v103
    v_cvt_pk_bf16_f32 v164, v104, v105
    v_cvt_pk_bf16_f32 v165, v106, v107
    v_cvt_pk_bf16_f32 v166, v108, v109
    v_cvt_pk_bf16_f32 v167, v110, v111
    v_cvt_pk_bf16_f32 v168, v112, v113
    v_cvt_pk_bf16_f32 v169, v114, v115
    v_cvt_pk_bf16_f32 v170, v116, v117
    v_cvt_pk_bf16_f32 v171, v118, v119
    v_cvt_pk_bf16_f32 v172, v120, v121
    v_cvt_pk_bf16_f32 v173, v122, v123
    v_cvt_pk_bf16_f32 v174, v124, v125
    v_cvt_pk_bf16_f32 v175, v126, v127
    v_and_b32 v12, 31, v1
    v_lshlrev_b32 v12, 4, v12
    v_mfma_f32_32x32x16_bf16 v[128:143], v[192:195], v[160:163], 0
    v_mfma_f32_32x32x16_bf16 v[128:143], v[196:199], v[164:167], v[128:143]
    v_mfma_f32_32x32x16_bf16 v[144:159], v[200:203], v[168:171], 0
    v_mfma_f32_32x32x16_bf16 v[144:159], v[204:207], v[172:175], v[144:159]
    v_lshl_add_u32 v13, v57, 30, v12
    v_lshl_add_u32 v12, v57, 11, v12
    v_pk_mul_f32 v[176:177], v[64:65], v[64:65]
    v_pk_mul_f32 v[178:179], v[66:67], v[66:67]
    v_pk_mul_f32 v[180:181], v[68:69], v[68:69]
    v_pk_mul_f32 v[182:183], v[70:71], v[70:71]
    v_pk_fma_f32 v[176:177], v[176:177], v[46:47], v[44:45] op_sel_hi:[1,0,0]
    v_pk_fma_f32 v[178:179], v[178:179], v[46:47], v[44:45] op_sel_hi:[1,0,0]
    v_pk_fma_f32 v[180:181], v[180:181], v[46:47], v[44:45] op_sel_hi:[1,0,0]
    v_pk_fma_f32 v[182:183], v[182:183], v[46:47], v[44:45] op_sel_hi:[1,0,0]
    v_pk_mul_f32 v[176:177], v[176:177], v[64:65]
    v_pk_mul_f32 v[178:179], v[178:179], v[66:67]
    v_pk_mul_f32 v[180:181], v[180:181], v[68:69]
    v_pk_mul_f32 v[182:183], v[182:183], v[70:71]
    v_exp_f32 v176, v176
    v_exp_f32 v177, v177
    v_exp_f32 v178, v178
    s_add_u32 s74, s52, 384
    s_and_b32 s74, s74, 0x3ff
    s_mul_i32 s74, s74, s12
    s_add_u32 m0, s3, 155648
    s_add_u32 s74, s74, s57
    buffer_load_dwordx4 v24, s[8:11], s74 offen offset:0 lds
    v_exp_f32 v179, v179
    v_exp_f32 v180, v180
    v_exp_f32 v181, v181
    v_exp_f32 v182, v182
    v_exp_f32 v183, v183
    v_pk_fma_f32 v[176:177], v[176:177], v[48:49], v[48:49] op_sel_hi:[1,0,0]
    v_pk_fma_f32 v[178:179], v[178:179], v[48:49], v[48:49] op_sel_hi:[1,0,0]
    v_pk_fma_f32 v[180:181], v[180:181], v[48:49], v[48:49] op_sel_hi:[1,0,0]
    v_pk_fma_f32 v[182:183], v[182:183], v[48:49], v[48:49] op_sel_hi:[1,0,0]
    v_rcp_f32 v176, v176
    v_rcp_f32 v177, v177
    buffer_load_dwordx4 v25, s[8:11], s74 offen offset:1024 lds
    v_rcp_f32 v178, v178
    v_rcp_f32 v179, v179
    v_rcp_f32 v180, v180
    v_rcp_f32 v181, v181
    v_rcp_f32 v182, v182
    v_rcp_f32 v183, v183
    v_pk_mul_f32 v[64:65], v[176:177], v[64:65]
    v_pk_mul_f32 v[66:67], v[178:179], v[66:67]
    v_pk_mul_f32 v[68:69], v[180:181], v[68:69]
    v_pk_mul_f32 v[70:71], v[182:183], v[70:71]
    v_pk_mul_f32 v[176:177], v[72:73], v[72:73]
    s_add_u32 m0, s54, 8192
    s_add_u32 s75, s85, 256
    buffer_load_dwordx4 v16, s[16:19], s75 offen offset:0 lds
    v_pk_mul_f32 v[178:179], v[74:75], v[74:75]
    v_pk_mul_f32 v[180:181], v[76:77], v[76:77]
    v_pk_mul_f32 v[182:183], v[78:79], v[78:79]
    v_pk_fma_f32 v[176:177], v[176:177], v[46:47], v[44:45] op_sel_hi:[1,0,0]
    v_pk_fma_f32 v[178:179], v[178:179], v[46:47], v[44:45] op_sel_hi:[1,0,0]
    v_pk_fma_f32 v[180:181], v[180:181], v[46:47], v[44:45] op_sel_hi:[1,0,0]
    v_pk_fma_f32 v[182:183], v[182:183], v[46:47], v[44:45] op_sel_hi:[1,0,0]
    v_pk_mul_f32 v[176:177], v[176:177], v[72:73]
    v_pk_mul_f32 v[178:179], v[178:179], v[74:75]
    v_pk_mul_f32 v[180:181], v[180:181], v[76:77]
    v_pk_mul_f32 v[182:183], v[182:183], v[78:79]
    v_exp_f32 v176, v176
    v_exp_f32 v177, v177
    v_exp_f32 v178, v178
    buffer_load_dwordx4 v17, s[16:19], s75 offen offset:1024 lds
    v_exp_f32 v179, v179
    v_exp_f32 v180, v180
    v_exp_f32 v181, v181
    v_exp_f32 v182, v182
    v_exp_f32 v183, v183
    v_pk_fma_f32 v[176:177], v[176:177], v[48:49], v[48:49] op_sel_hi:[1,0,0]
    v_pk_fma_f32 v[178:179], v[178:179], v[48:49], v[48:49] op_sel_hi:[1,0,0]
    v_pk_fma_f32 v[180:181], v[180:181], v[48:49], v[48:49] op_sel_hi:[1,0,0]
    v_pk_fma_f32 v[182:183], v[182:183], v[48:49], v[48:49] op_sel_hi:[1,0,0]
    v_rcp_f32 v176, v176
    v_rcp_f32 v177, v177
    buffer_load_dwordx4 v18, s[16:19], s75 offen offset:2048 lds
    v_rcp_f32 v178, v178
    v_rcp_f32 v179, v179
    v_rcp_f32 v180, v180
    v_rcp_f32 v181, v181
    v_rcp_f32 v182, v182
    v_rcp_f32 v183, v183
    v_pk_mul_f32 v[72:73], v[176:177], v[72:73]
    v_pk_mul_f32 v[74:75], v[178:179], v[74:75]
    v_pk_mul_f32 v[76:77], v[180:181], v[76:77]
    v_pk_mul_f32 v[78:79], v[182:183], v[78:79]
    v_pk_mul_f32 v[176:177], v[80:81], v[80:81]
    buffer_load_dwordx4 v19, s[16:19], s75 offen offset:3072 lds
    v_pk_mul_f32 v[178:179], v[82:83], v[82:83]
    v_pk_mul_f32 v[180:181], v[84:85], v[84:85]
    v_pk_mul_f32 v[182:183], v[86:87], v[86:87]
    v_pk_fma_f32 v[176:177], v[176:177], v[46:47], v[44:45] op_sel_hi:[1,0,0]
    v_pk_fma_f32 v[178:179], v[178:179], v[46:47], v[44:45] op_sel_hi:[1,0,0]
    v_pk_fma_f32 v[180:181], v[180:181], v[46:47], v[44:45] op_sel_hi:[1,0,0]
    v_pk_fma_f32 v[182:183], v[182:183], v[46:47], v[44:45] op_sel_hi:[1,0,0]
    v_pk_mul_f32 v[176:177], v[176:177], v[80:81]
    v_pk_mul_f32 v[178:179], v[178:179], v[82:83]
    v_pk_mul_f32 v[180:181], v[180:181], v[84:85]
    v_pk_mul_f32 v[182:183], v[182:183], v[86:87]
    v_exp_f32 v176, v176
    v_exp_f32 v177, v177
    v_exp_f32 v178, v178
    s_add_u32 m0, s54, 20480
    s_add_u32 s74, s81, 512
    buffer_load_dwordx4 v16, s[16:19], s74 offen offset:0 lds
    v_exp_f32 v179, v179
    v_exp_f32 v180, v180
    v_exp_f32 v181, v181
    v_exp_f32 v182, v182
    v_exp_f32 v183, v183
    v_pk_fma_f32 v[176:177], v[176:177], v[48:49], v[48:49] op_sel_hi:[1,0,0]
    v_pk_fma_f32 v[178:179], v[178:179], v[48:49], v[48:49] op_sel_hi:[1,0,0]
    v_pk_fma_f32 v[180:181], v[180:181], v[48:49], v[48:49] op_sel_hi:[1,0,0]
    v_pk_fma_f32 v[182:183], v[182:183], v[48:49], v[48:49] op_sel_hi:[1,0,0]
    v_rcp_f32 v176, v176
    v_rcp_f32 v177, v177
    buffer_load_dwordx4 v17, s[16:19], s74 offen offset:1024 lds
    v_rcp_f32 v178, v178
    v_rcp_f32 v179, v179
    v_rcp_f32 v180, v180
    v_rcp_f32 v181, v181
    v_rcp_f32 v182, v182
    v_rcp_f32 v183, v183
    v_pk_mul_f32 v[80:81], v[176:177], v[80:81]
    v_pk_mul_f32 v[82:83], v[178:179], v[82:83]
    v_pk_mul_f32 v[84:85], v[180:181], v[84:85]
    v_pk_mul_f32 v[86:87], v[182:183], v[86:87]
    v_pk_mul_f32 v[176:177], v[88:89], v[88:89]
    buffer_load_dwordx4 v18, s[16:19], s74 offen offset:2048 lds
    v_pk_mul_f32 v[178:179], v[90:91], v[90:91]
    v_pk_mul_f32 v[180:181], v[92:93], v[92:93]
    v_pk_mul_f32 v[182:183], v[94:95], v[94:95]
    v_pk_fma_f32 v[176:177], v[176:177], v[46:47], v[44:45] op_sel_hi:[1,0,0]
    v_pk_fma_f32 v[178:179], v[178:179], v[46:47], v[44:45] op_sel_hi:[1,0,0]
    v_pk_fma_f32 v[180:181], v[180:181], v[46:47], v[44:45] op_sel_hi:[1,0,0]
    v_pk_fma_f32 v[182:183], v[182:183], v[46:47], v[44:45] op_sel_hi:[1,0,0]
    v_pk_mul_f32 v[176:177], v[176:177], v[88:89]
    v_pk_mul_f32 v[178:179], v[178:179], v[90:91]
    v_pk_mul_f32 v[180:181], v[180:181], v[92:93]
    v_pk_mul_f32 v[182:183], v[182:183], v[94:95]
    v_exp_f32 v176, v176
    v_exp_f32 v177, v177
    v_exp_f32 v178, v178
    buffer_load_dwordx4 v19, s[16:19], s74 offen offset:3072 lds
    v_exp_f32 v179, v179
    v_exp_f32 v180, v180
    v_exp_f32 v181, v181
    v_exp_f32 v182, v182
    v_exp_f32 v183, v183
    v_pk_fma_f32 v[176:177], v[176:177], v[48:49], v[48:49] op_sel_hi:[1,0,0]
    v_pk_fma_f32 v[178:179], v[178:179], v[48:49], v[48:49] op_sel_hi:[1,0,0]
    v_pk_fma_f32 v[180:181], v[180:181], v[48:49], v[48:49] op_sel_hi:[1,0,0]
    v_pk_fma_f32 v[182:183], v[182:183], v[48:49], v[48:49] op_sel_hi:[1,0,0]
    v_rcp_f32 v176, v176
    v_rcp_f32 v177, v177
    s_lshl_b32 s80, s2, 2
    s_add_u32 s80, s80, s48
    s_lshl_b32 s80, s80, 10
    buffer_load_dwordx4 a[252:255], v0, s[28:31], s80 offen
    v_rcp_f32 v178, v178
    v_rcp_f32 v179, v179
    v_rcp_f32 v180, v180
    v_rcp_f32 v181, v181
    v_rcp_f32 v182, v182
    v_rcp_f32 v183, v183
    v_pk_mul_f32 v[88:89], v[176:177], v[88:89]
    v_pk_mul_f32 v[90:91], v[178:179], v[90:91]
    v_pk_mul_f32 v[92:93], v[180:181], v[92:93]
    v_pk_mul_f32 v[94:95], v[182:183], v[94:95]
    s_cmp_eq_u32 s61, 0
    s_cbranch_scc1 Lz1_4
    v_pk_add_f32 v[208:209], v[64:65], v[66:67]
    v_pk_mul_f32 v[210:211], v[64:65], v[64:65]
    v_pk_fma_f32 v[210:211], v[66:67], v[66:67], v[210:211]
    v_pk_add_f32 v[208:209], v[208:209], v[68:69]
    v_pk_fma_f32 v[210:211], v[68:69], v[68:69], v[210:211]
    v_pk_add_f32 v[208:209], v[208:209], v[70:71]
    v_pk_fma_f32 v[210:211], v[70:71], v[70:71], v[210:211]
    v_pk_mul_f32 v[208:209], v[208:209], s[62:63] op_sel_hi:[1,0]
    v_pk_mul_f32 v[210:211], v[210:211], s[62:63] op_sel_hi:[1,0]
    v_pk_add_f32 v[208:209], v[208:209], v[72:73]
    v_pk_fma_f32 v[210:211], v[72:73], v[72:73], v[210:211]
    v_pk_add_f32 v[208:209], v[208:209], v[74:75]
    v_pk_fma_f32 v[210:211], v[74:75], v[74:75], v[210:211]
    v_pk_add_f32 v[208:209], v[208:209], v[76:77]
    v_pk_fma_f32 v[210:211], v[76:77], v[76:77], v[210:211]
    v_pk_add_f32 v[208:209], v[208:209], v[78:79]
    v_pk_fma_f32 v[210:211], v[78:79], v[78:79], v[210:211]
    v_pk_add_f32 v[208:209], v[208:209], v[80:81]
    v_pk_fma_f32 v[210:211], v[80:81], v[80:81], v[210:211]
    v_pk_add_f32 v[208:209], v[208:209], v[82:83]
    v_pk_fma_f32 v[210:211], v[82:83], v[82:83], v[210:211]
    v_pk_add_f32 v[208:209], v[208:209], v[84:85]
    v_pk_fma_f32 v[210:211], v[84:85], v[84:85], v[210:211]
    v_pk_add_f32 v[208:209], v[208:209], v[86:87]
    v_pk_fma_f32 v[210:211], v[86:87], v[86:87], v[210:211]
    v_pk_add_f32 v[208:209], v[208:209], v[88:89]
    v_pk_fma_f32 v[210:211], v[88:89], v[88:89], v[210:211]
    v_pk_add_f32 v[208:209], v[208:209], v[90:91]
    v_pk_fma_f32 v[210:211], v[90:91], v[90:91], v[210:211]
    v_pk_add_f32 v[208:209], v[208:209], v[92:93]
    v_pk_fma_f32 v[210:211], v[92:93], v[92:93], v[210:211]
    v_pk_add_f32 v[208:209], v[208:209], v[94:95]
    v_pk_fma_f32 v[210:211], v[94:95], v[94:95], v[210:211]
    v_add_f32 v212, v208, v209
    v_add_f32 v213, v210, v211
    v_mov_b32 v214, s53
    s_nop 1
    v_permlane32_swap_b32 v212, v213
    v_add_f32 v213, v212, v213
    v_mov_b32 v212, v213
    s_nop 1
    v_permlane32_swap_b32 v212, v213
    buffer_store_dwordx4 v[212:215], v13, s[20:23], s70 offen sc1
Lj_5:
    v_max3_f32 v2, v128, v129, v130
    v_min3_f32 v3, v128, v129, v130
    v_max3_f32 v2, v2, v131, v132
    v_min3_f32 v3, v3, v131, v132
    v_max3_f32 v2, v2, v133, v134
    v_min3_f32 v3, v3, v133, v134
    v_max3_f32 v2, v2, v135, v136
    v_min3_f32 v3, v3, v135, v136
    v_max3_f32 v2, v2, v137, v138
    v_min3_f32 v3, v3, v137, v138
    v_max3_f32 v2, v2, v139, v140
    v_min3_f32 v3, v3, v139, v140
    v_max3_f32 v2, v2, v141, v142
    v_min3_f32 v3, v3, v141, v142
    v_max_f32 v2, v2, v143
    v_min_f32 v3, v3, v143
    v_mul_f32 v4, v2, -v58
    s_add_u32 m0, s54, 24576
    s_add_u32 s75, s85, 512
    buffer_load_dwordx4 v16, s[16:19], s75 offen offset:0 lds
    v_mul_f32 v6, v3, v58
    v_pk_fma_f32 v[160:161], v[128:129], v[58:59], v[4:5] op_sel_hi:[1,0,0]
    v_pk_fma_f32 v[176:177], v[128:129], v[58:59], v[6:7] op_sel_hi:[1,0,0] neg_lo:[0,1,0] neg_hi:[0,1,0]
    v_pk_fma_f32 v[162:163], v[130:131], v[58:59], v[4:5] op_sel_hi:[1,0,0]
    v_pk_fma_f32 v[178:179], v[130:131], v[58:59], v[6:7] op_sel_hi:[1,0,0] neg_lo:[0,1,0] neg_hi:[0,1,0]
    v_pk_fma_f32 v[164:165], v[132:133], v[58:59], v[4:5] op_sel_hi:[1,0,0]
    v_pk_fma_f32 v[180:181], v[132:133], v[58:59], v[6:7] op_sel_hi:[1,0,0] neg_lo:[0,1,0] neg_hi:[0,1,0]
    v_pk_fma_f32 v[166:167], v[134:135], v[58:59], v[4:5] op_sel_hi:[1,0,0]
    v_pk_fma_f32 v[182:183], v[134:135], v[58:59], v[6:7] op_sel_hi:[1,0,0] neg_lo:[0,1,0] neg_hi:[0,1,0]
    v_pk_fma_f32 v[168:169], v[136:137], v[58:59], v[4:5] op_sel_hi:[1,0,0]
    v_pk_fma_f32 v[184:185], v[136:137], v[58:59], v[6:7] op_sel_hi:[1,0,0] neg_lo:[0,1,0] neg_hi:[0,1,0]
    v_pk_fma_f32 v[170:171], v[138:139], v[58:59], v[4:5] op_sel_hi:[1,0,0]
    v_pk_fma_f32 v[186:187], v[138:139], v[58:59], v[6:7] op_sel_hi:[1,0,0] neg_lo:[0,1,0] neg_hi:[0,1,0]
    v_pk_fma_f32 v[172:173], v[140:141], v[58:59], v[4:5] op_sel_hi:[1,0,0]
    v_pk_fma_f32 v[188:189], v[140:141], v[58:59], v[6:7] op_sel_hi:[1,0,0] neg_lo:[0,1,0] neg_hi:[0,1,0]
    v_pk_fma_f32 v[174:175], v[142:143], v[58:59], v[4:5] op_sel_hi:[1,0,0]
    v_pk_fma_f32 v[190:191], v[142:143], v[58:59], v[6:7] op_sel_hi:[1,0,0] neg_lo:[0,1,0] neg_hi:[0,1,0]
    buffer_load_dwordx4 v17, s[16:19], s75 offen offset:1024 lds
    v_exp_f32 v160, v160
    v_exp_f32 v161, v161
    v_exp_f32 v162, v162
    v_exp_f32 v163, v163
    v_exp_f32 v164, v164
    v_exp_f32 v165, v165
    v_exp_f32 v166, v166
    v_exp_f32 v167, v167
    v_exp_f32 v168, v168
    buffer_load_dwordx4 v18, s[16:19], s75 offen offset:2048 lds
    v_exp_f32 v169, v169
    v_exp_f32 v170, v170
    v_exp_f32 v171, v171
    v_exp_f32 v172, v172
    v_exp_f32 v173, v173
    v_exp_f32 v174, v174
    v_exp_f32 v175, v175
    v_exp_f32 v176, v176
    v_exp_f32 v177, v177
    buffer_load_dwordx4 v19, s[16:19], s75 offen offset:3072 lds
    v_exp_f32 v178, v178
    v_exp_f32 v179, v179
    v_exp_f32 v180, v180
    v_exp_f32 v181, v181
    v_exp_f32 v182, v182
    v_exp_f32 v183, v183
    v_exp_f32 v184, v184
    v_exp_f32 v185, v185
    v_exp_f32 v186, v186
    s_add_u32 m0, s54, 28672
    s_add_u32 s74, s81, 768
    buffer_load_dwordx4 v16, s[16:19], s74 offen offset:0 lds
    v_exp_f32 v187, v187
    v_exp_f32 v188, v188
    v_exp_f32 v189, v189
    v_exp_f32 v190, v190
    v_exp_f32 v191, v191
    v_pk_add_f32 v[8:9], v[160:161], v[162:163]
    v_pk_add_f32 v[10:11], v[176:177], v[178:179]
    v_pk_add_f32 v[8:9], v[8:9], v[164:165]
    v_pk_add_f32 v[10:11], v[10:11], v[180:181]
    v_pk_add_f32 v[8:9], v[8:9], v[166:167]
    v_pk_add_f32 v[10:11], v[10:11], v[182:183]
    v_pk_add_f32 v[8:9], v[8:9], v[168:169]
    buffer_load_dwordx4 v17, s[16:19], s74 offen offset:1024 lds
    v_pk_add_f32 v[10:11], v[10:11], v[184:185]
    v_pk_add_f32 v[8:9], v[8:9], v[170:171]
    v_pk_add_f32 v[10:11], v[10:11], v[186:187]
    v_pk_add_f32 v[8:9], v[8:9], v[172:173]
    v_pk_add_f32 v[10:11], v[10:11], v[188:189]
    v_pk_add_f32 v[8:9], v[8:9], v[174:175]
    v_pk_add_f32 v[10:11], v[10:11], v[190:191]
    v_add_f32 v8, v8, v9
    v_add_f32 v10, v10, v11
    v_rcp_f32 v8, v8
    v_rcp_f32 v10, v10
    s_nop 0
    v_pk_mul_f32 v[160:161], v[160:161], v[8:9] op_sel_hi:[1,0]
    v_pk_mul_f32 v[162:163], v[162:163], v[8:9] op_sel_hi:[1,0]
    v_pk_mul_f32 v[164:165], v[164:165], v[8:9] op_sel_hi:[1,0]
    v_pk_mul_f32 v[166:167], v[166:167], v[8:9] op_sel_hi:[1,0]
    buffer_load_dwordx4 v18, s[16:19], s74 offen offset:2048 lds
    v_pk_mul_f32 v[168:169], v[168:169], v[8:9] op_sel_hi:[1,0]
    v_pk_mul_f32 v[170:171], v[170:171], v[8:9] op_sel_hi:[1,0]
    v_pk_mul_f32 v[172:173], v[172:173], v[8:9] op_sel_hi:[1,0]
    v_pk_mul_f32 v[174:175], v[174:175], v[8:9] op_sel_hi:[1,0]
    v_pk_mul_f32 v[176:177], v[176:177], v[10:11] op_sel_hi:[1,0]
    v_pk_mul_f32 v[178:179], v[178:179], v[10:11] op_sel_hi:[1,0]
    v_pk_mul_f32 v[180:181], v[180:181], v[10:11] op_sel_hi:[1,0]
    v_pk_mul_f32 v[182:183], v[182:183], v[10:11] op_sel_hi:[1,0]
    v_pk_mul_f32 v[184:185], v[184:185], v[10:11] op_sel_hi:[1,0]
    v_pk_mul_f32 v[186:187], v[186:187], v[10:11] op_sel_hi:[1,0]
    v_pk_mul_f32 v[188:189], v[188:189], v[10:11] op_sel_hi:[1,0]
    v_pk_mul_f32 v[190:191], v[190:191], v[10:11] op_sel_hi:[1,0]
    v_cvt_pk_bf16_f32 v224, v160, v161
    v_cvt_pk_bf16_f32 v225, v162, v163
    v_cvt_pk_bf16_f32 v226, v164, v165
    v_cvt_pk_bf16_f32 v227, v166, v167
    v_cvt_pk_bf16_f32 v228, v168, v169
    buffer_load_dwordx4 v19, s[16:19], s74 offen offset:3072 lds
    v_cvt_pk_bf16_f32 v229, v170, v171
    v_cvt_pk_bf16_f32 v230, v172, v173
    v_cvt_pk_bf16_f32 v231, v174, v175
    v_cvt_pk_bf16_f32 v232, v176, v177
    v_cvt_pk_bf16_f32 v233, v178, v179
    v_cvt_pk_bf16_f32 v234, v180, v181
    v_cvt_pk_bf16_f32 v235, v182, v183
    v_cvt_pk_bf16_f32 v236, v184, v185
    v_cvt_pk_bf16_f32 v237, v186, v187
    v_cvt_pk_bf16_f32 v238, v188, v189
    v_cvt_pk_bf16_f32 v239, v190, v191
    s_waitcnt vmcnt(33)
    ds_read_b128 a[128:131], v20 offset:0
    ds_read_b128 a[132:135], v21 offset:0
    ds_read_b128 a[136:139], v22 offset:0
    ds_read_b128 a[140:143], v23 offset:0
    v_max3_f32 v2, v144, v145, v146
    v_min3_f32 v3, v144, v145, v146
    v_max3_f32 v2, v2, v147, v148
    v_min3_f32 v3, v3, v147, v148
    v_max3_f32 v2, v2, v149, v150
    v_min3_f32 v3, v3, v149, v150
    v_max3_f32 v2, v2, v151, v152
    v_min3_f32 v3, v3, v151, v152
    v_max3_f32 v2, v2, v153, v154
    v_min3_f32 v3, v3, v153, v154
    v_max3_f32 v2, v2, v155, v156
    v_min3_f32 v3, v3, v155, v156
    v_max3_f32 v2, v2, v157, v158
    v_min3_f32 v3, v3, v157, v158
    v_max_f32 v2, v2, v159
    v_min_f32 v3, v3, v159
    s_lshl_b32 s80, s2, 2
    s_add_u32 s80, s80, s48
    s_lshl_b32 s80, s80, 10
    buffer_load_dwordx4 a[252:255], v0, s[32:35], s80 offen
    v_mul_f32 v4, v2, -v58
    v_mul_f32 v6, v3, v58
    v_pk_fma_f32 v[160:161], v[144:145], v[58:59], v[4:5] op_sel_hi:[1,0,0]
    v_pk_fma_f32 v[176:177], v[144:145], v[58:59], v[6:7] op_sel_hi:[1,0,0] neg_lo:[0,1,0] neg_hi:[0,1,0]
    v_pk_fma_f32 v[162:163], v[146:147], v[58:59], v[4:5] op_sel_hi:[1,0,0]
    v_pk_fma_f32 v[178:179], v[146:147], v[58:59], v[6:7] op_sel_hi:[1,0,0] neg_lo:[0,1,0] neg_hi:[0,1,0]
    v_pk_fma_f32 v[164:165], v[148:149], v[58:59], v[4:5] op_sel_hi:[1,0,0]
    v_pk_fma_f32 v[180:181], v[148:149], v[58:59], v[6:7] op_sel_hi:[1,0,0] neg_lo:[0,1,0] neg_hi:[0,1,0]
    v_pk_fma_f32 v[166:167], v[150:151], v[58:59], v[4:5] op_sel_hi:[1,0,0]
    v_pk_fma_f32 v[182:183], v[150:151], v[58:59], v[6:7] op_sel_hi:[1,0,0] neg_lo:[0,1,0] neg_hi:[0,1,0]
    v_pk_fma_f32 v[168:169], v[152:153], v[58:59], v[4:5] op_sel_hi:[1,0,0]
    v_pk_fma_f32 v[184:185], v[152:153], v[58:59], v[6:7] op_sel_hi:[1,0,0] neg_lo:[0,1,0] neg_hi:[0,1,0]
    v_pk_fma_f32 v[170:171], v[154:155], v[58:59], v[4:5] op_sel_hi:[1,0,0]
    v_pk_fma_f32 v[186:187], v[154:155], v[58:59], v[6:7] op_sel_hi:[1,0,0] neg_lo:[0,1,0] neg_hi:[0,1,0]
    v_pk_fma_f32 v[172:173], v[156:157], v[58:59], v[4:5] op_sel_hi:[1,0,0]
    v_pk_fma_f32 v[188:189], v[156:157], v[58:59], v[6:7] op_sel_hi:[1,0,0] neg_lo:[0,1,0] neg_hi:[0,1,0]
    s_waitcnt vmcnt(27)
    ds_read_b128 a[144:147], v20 offset:4096
    ds_read_b128 a[148:151], v21 offset:4096
    ds_read_b128 a[152:155], v22 offset:4096
    ds_read_b128 a[156:159], v23 offset:4096
    s_waitcnt lgkmcnt(4)
    s_add_u32 m0, s54, 0
    s_add_u32 s75, s85, 768
    buffer_load_dwordx4 v16, s[16:19], s75 offen offset:0 lds
    v_pk_fma_f32 v[174:175], v[158:159], v[58:59], v[4:5] op_sel_hi:[1,0,0]
    v_pk_fma_f32 v[190:191], v[158:159], v[58:59], v[6:7] op_sel_hi:[1,0,0] neg_lo:[0,1,0] neg_hi:[0,1,0]
    v_exp_f32 v160, v160
    v_exp_f32 v161, v161
    v_exp_f32 v162, v162
    v_exp_f32 v163, v163
    v_exp_f32 v164, v164
    v_exp_f32 v165, v165
    v_exp_f32 v166, v166
    buffer_load_dwordx4 v17, s[16:19], s75 offen offset:1024 lds
    v_exp_f32 v167, v167
    v_exp_f32 v168, v168
    v_exp_f32 v169, v169
    v_exp_f32 v170, v170
    v_exp_f32 v171, v171
    v_exp_f32 v172, v172
    v_exp_f32 v173, v173
    v_exp_f32 v174, v174
    buffer_load_dwordx4 v18, s[16:19], s75 offen offset:2048 lds
    v_exp_f32 v175, v175
    v_exp_f32 v176, v176
    v_exp_f32 v177, v177
    v_exp_f32 v178, v178
    v_exp_f32 v179, v179
    v_exp_f32 v180, v180
    v_exp_f32 v181, v181
    v_exp_f32 v182, v182
    buffer_load_dwordx4 v19, s[16:19], s75 offen offset:3072 lds
    v_exp_f32 v183, v183
    v_exp_f32 v184, v184
    v_exp_f32 v185, v185
    v_exp_f32 v186, v186
    v_exp_f32 v187, v187
    v_exp_f32 v188, v188
    v_exp_f32 v189, v189
    v_exp_f32 v190, v190
    s_waitcnt vmcnt(25)
    ds_read_b128 a[160:163], v20 offset:16384
    ds_read_b128 a[164:167], v21 offset:16384
    ds_read_b128 a[168:171], v22 offset:16384
    ds_read_b128 a[172:175], v23 offset:16384
    s_waitcnt lgkmcnt(4)
    s_add_u32 m0, s54, 4096
    s_add_u32 s74, s81, 1024
    buffer_load_dwordx4 v16, s[16:19], s74 offen offset:0 lds
    v_exp_f32 v191, v191
    v_pk_add_f32 v[8:9], v[160:161], v[162:163]
    v_pk_add_f32 v[10:11], v[176:177], v[178:179]
    v_pk_add_f32 v[8:9], v[8:9], v[164:165]
    v_pk_add_f32 v[10:11], v[10:11], v[180:181]
    v_pk_add_f32 v[8:9], v[8:9], v[166:167]
    v_pk_add_f32 v[10:11], v[10:11], v[182:183]
    v_pk_add_f32 v[8:9], v[8:9], v[168:169]
    v_pk_add_f32 v[10:11], v[10:11], v[184:185]
    v_pk_add_f32 v[8:9], v[8:9], v[170:171]
    v_pk_add_f32 v[10:11], v[10:11], v[186:187]
    v_pk_add_f32 v[8:9], v[8:9], v[172:173]
    v_pk_add_f32 v[10:11], v[10:11], v[188:189]
    v_pk_add_f32 v[8:9], v[8:9], v[174:175]
    v_pk_add_f32 v[10:11], v[10:11], v[190:191]
    buffer_load_dwordx4 v17, s[16:19], s74 offen offset:1024 lds
    v_add_f32 v8, v8, v9
    v_add_f32 v10, v10, v11
    v_rcp_f32 v8, v8
    v_rcp_f32 v10, v10
    s_nop 0
    v_pk_mul_f32 v[160:161], v[160:161], v[8:9] op_sel_hi:[1,0]
    v_pk_mul_f32 v[162:163], v[162:163], v[8:9] op_sel_hi:[1,0]
    v_pk_mul_f32 v[164:165], v[164:165], v[8:9] op_sel_hi:[1,0]
    v_pk_mul_f32 v[166:167], v[166:167], v[8:9] op_sel_hi:[1,0]
    v_pk_mul_f32 v[168:169], v[168:169], v[8:9] op_sel_hi:[1,0]
    v_pk_mul_f32 v[170:171], v[170:171], v[8:9] op_sel_hi:[1,0]
    v_pk_mul_f32 v[172:173], v[172:173], v[8:9] op_sel_hi:[1,0]
    v_pk_mul_f32 v[174:175], v[174:175], v[8:9] op_sel_hi:[1,0]
    v_pk_mul_f32 v[176:177], v[176:177], v[10:11] op_sel_hi:[1,0]
    v_pk_mul_f32 v[178:179], v[178:179], v[10:11] op_sel_hi:[1,0]
    buffer_load_dwordx4 v18, s[16:19], s74 offen offset:2048 lds
    v_pk_mul_f32 v[180:181], v[180:181], v[10:11] op_sel_hi:[1,0]
    v_pk_mul_f32 v[182:183], v[182:183], v[10:11] op_sel_hi:[1,0]
    v_pk_mul_f32 v[184:185], v[184:185], v[10:11] op_sel_hi:[1,0]
    v_pk_mul_f32 v[186:187], v[186:187], v[10:11] op_sel_hi:[1,0]
    v_pk_mul_f32 v[188:189], v[188:189], v[10:11] op_sel_hi:[1,0]
    v_pk_mul_f32 v[190:191], v[190:191], v[10:11] op_sel_hi:[1,0]
    v_cvt_pk_bf16_f32 v240, v160, v161
    v_cvt_pk_bf16_f32 v241, v162, v163
    v_cvt_pk_bf16_f32 v242, v164, v165
    v_cvt_pk_bf16_f32 v243, v166, v167
    v_cvt_pk_bf16_f32 v244, v168, v169
    v_cvt_pk_bf16_f32 v245, v170, v171
    v_cvt_pk_bf16_f32 v246, v172, v173
    v_cvt_pk_bf16_f32 v247, v174, v175
    v_cvt_pk_bf16_f32 v248, v176, v177
    v_cvt_pk_bf16_f32 v249, v178, v179
    buffer_load_dwordx4 v19, s[16:19], s74 offen offset:3072 lds
    v_cvt_pk_bf16_f32 v250, v180, v181
    v_cvt_pk_bf16_f32 v251, v182, v183
    v_cvt_pk_bf16_f32 v252, v184, v185
    v_cvt_pk_bf16_f32 v253, v186, v187
    v_cvt_pk_bf16_f32 v254, v188, v189
    v_cvt_pk_bf16_f32 v255, v190, v191
    ds_read_b64_tr_b16 v[192:193], v32 offset:0
    ds_read_b64_tr_b16 v[194:195], v32 offset:512
    ds_read_b64_tr_b16 v[196:197], v33 offset:0
    ds_read_b64_tr_b16 v[198:199], v33 offset:512
    s_barrier
    ds_read_b64_tr_b16 v[160:161], v30 offset:0
    ds_read_b64_tr_b16 v[162:163], v30 offset:512
    ds_read_b64_tr_b16 v[164:165], v31 offset:0
    ds_read_b64_tr_b16 v[166:167], v31 offset:512
    ds_read_b64_tr_b16 v[168:169], v30 offset:2048
    ds_read_b64_tr_b16 v[170:171], v30 offset:2560
    ds_read_b64_tr_b16 v[172:173], v31 offset:2048
    ds_read_b64_tr_b16 v[174:175], v31 offset:2560
    ds_read_b64_tr_b16 v[176:177], v30 offset:4096
    ds_read_b64_tr_b16 v[178:179], v30 offset:4608
    ds_read_b64_tr_b16 v[180:181], v31 offset:4096
    ds_read_b64_tr_b16 v[182:183], v31 offset:4608
    s_waitcnt lgkmcnt(12)
    v_dot2c_f32_bf16 v40, s55, v192
    v_dot2c_f32_bf16 v41, s55, v196
    v_dot2c_f32_bf16 v40, s55, v193
    v_dot2c_f32_bf16 v41, s55, v197
    v_dot2c_f32_bf16 v40, s55, v194
    v_dot2c_f32_bf16 v41, s55, v198
    v_dot2c_f32_bf16 v40, s55, v195
    v_dot2c_f32_bf16 v41, s55, v199
    s_waitcnt lgkmcnt(8)
    v_mfma_f32_32x32x16_bf16 v[128:143], v[160:163], a[0:3], 0
    ds_read_b64_tr_b16 v[184:185], v30 offset:6144
    ds_read_b64_tr_b16 v[186:187], v30 offset:6656
    s_add_u32 s68, s82, 0
    ds_read_b64_tr_b16 v[192:193], v32 offset:8192
    v_mfma_f32_32x32x16_bf16 v[144:159], v[164:167], a[0:3], 0
    ds_read_b64_tr_b16 v[188:189], v31 offset:6144
    ds_read_b64_tr_b16 v[190:191], v31 offset:6656
    buffer_load_dwordx4 v[96:99], v12, s[20:23], s68 offen sc1
    s_add_u32 s68, s82, 4096
    s_waitcnt lgkmcnt(9)
    v_mfma_f32_32x32x16_bf16 v[128:143], v[168:171], a[4:7], v[128:143]
    ds_read_b64_tr_b16 v[160:161], v30 offset:8192
    ds_read_b64_tr_b16 v[162:163], v30 offset:8704
    buffer_load_dwordx4 v[100:103], v12, s[20:23], s68 offen sc1
    ds_read_b64_tr_b16 v[194:195], v32 offset:8704
    s_add_u32 s68, s82, 8192
    v_mfma_f32_32x32x16_bf16 v[144:159], v[172:175], a[4:7], v[144:159]
    ds_read_b64_tr_b16 v[164:165], v31 offset:8192
    ds_read_b64_tr_b16 v[166:167], v31 offset:8704
    buffer_load_dwordx4 v[104:107], v12, s[20:23], s68 offen sc1
    s_waitcnt vmcnt(26)
    ds_read_b128 a[176:179], v20 offset:8192
    s_waitcnt lgkmcnt(11)
    v_mfma_f32_32x32x16_bf16 v[128:143], v[176:179], a[8:11], v[128:143]
    ds_read_b64_tr_b16 v[168:169], v30 offset:10240
    ds_read_b64_tr_b16 v[170:171], v30 offset:10752
    s_add_u32 s68, s82, 12288
    ds_read_b64_tr_b16 v[196:197], v33 offset:8192
    ds_read_b128 a[180:183], v21 offset:8192
    v_mfma_f32_32x32x16_bf16 v[144:159], v[180:183], a[8:11], v[144:159]
    ds_read_b64_tr_b16 v[172:173], v31 offset:10240
    ds_read_b64_tr_b16 v[174:175], v31 offset:10752
    buffer_load_dwordx4 v[108:111], v12, s[20:23], s68 offen sc1
    ds_read_b64_tr_b16 v[198:199], v33 offset:8704
    s_add_u32 s68, s82, 16384
    s_waitcnt lgkmcnt(13)
    v_mfma_f32_32x32x16_bf16 v[128:143], v[184:187], a[12:15], v[128:143]
    ds_read_b64_tr_b16 v[176:177], v30 offset:12288
    ds_read_b64_tr_b16 v[178:179], v30 offset:12800
    buffer_load_dwordx4 v[112:115], v12, s[20:23], s68 offen sc1
    ds_read_b128 a[184:187], v22 offset:8192
    s_add_u32 s68, s82, 20480
    v_mfma_f32_32x32x16_bf16 v[144:159], v[188:191], a[12:15], v[144:159]
    ds_read_b64_tr_b16 v[180:181], v31 offset:12288
    ds_read_b64_tr_b16 v[182:183], v31 offset:12800
    buffer_load_dwordx4 v[116:119], v13, s[20:23], s68 offen sc1
    ds_read_b128 a[188:191], v23 offset:8192
    s_waitcnt lgkmcnt(6)
    v_dot2c_f32_bf16 v40, s55, v192
    v_dot2c_f32_bf16 v41, s55, v196
    v_dot2c_f32_bf16 v40, s55, v193
    v_dot2c_f32_bf16 v41, s55, v197
    v_dot2c_f32_bf16 v40, s55, v194
    v_dot2c_f32_bf16 v41, s55, v198
    v_dot2c_f32_bf16 v40, s55, v195
    v_dot2c_f32_bf16 v41, s55, v199
    s_barrier
    v_mfma_f32_32x32x16_bf16 v[128:143], v[160:163], a[16:19], v[128:143]
    ds_read_b64_tr_b16 v[184:185], v30 offset:14336
    ds_read_b64_tr_b16 v[186:187], v30 offset:14848
    s_add_u32 s75, s52, 512
    ds_read_b64_tr_b16 v[192:193], v32 offset:16384
    s_lshr_b32 s68, s48, 1
    s_and_b32 s75, s75, 0x3ff
    v_mfma_f32_32x32x16_bf16 v[144:159], v[164:167], a[16:19], v[144:159]
    ds_read_b64_tr_b16 v[188:189], v31 offset:14336
    ds_read_b64_tr_b16 v[190:191], v31 offset:14848
    s_mul_i32 s75, s75, s12
    ds_read_b64_tr_b16 v[194:195], v32 offset:16896
    s_lshl_b32 s69, s68, 4
    v_xor_b32 v35, s69, v1
    s_add_u32 m0, s3, 131072
    s_add_u32 s75, s75, s57
    buffer_load_dwordx4 v24, s[8:11], s75 offen offset:0 lds
    v_mfma_f32_32x32x16_bf16 v[128:143], v[168:171], a[20:23], v[128:143]
    ds_read_b64_tr_b16 v[160:161], v30 offset:16384
    ds_read_b64_tr_b16 v[162:163], v30 offset:16896
    buffer_load_dwordx4 v25, s[8:11], s75 offen offset:1024 lds
    v_lshlrev_b32 v35, 4, v35
    s_and_b32 s70, s48, 1
    s_add_u32 m0, s54, 16384
    s_add_u32 s74, s85, 1024
    v_mfma_f32_32x32x16_bf16 v[144:159], v[172:175], a[20:23], v[144:159]
    ds_read_b64_tr_b16 v[164:165], v31 offset:16384
    ds_read_b64_tr_b16 v[166:167], v31 offset:16896
    buffer_load_dwordx4 v16, s[16:19], s74 offen offset:0 lds
    s_waitcnt vmcnt(28)
    ds_read_b128 a[192:195], v20 offset:20480
    s_add_u32 s69, s69, s70
    s_mul_i32 s71, s67, 3
    s_waitcnt lgkmcnt(12)
    v_mfma_f32_32x32x16_bf16 v[128:143], v[176:179], a[24:27], v[128:143]
    ds_read_b64_tr_b16 v[168:169], v30 offset:18432
    ds_read_b64_tr_b16 v[170:171], v30 offset:18944
    ds_read_b64_tr_b16 v[196:197], v33 offset:16384
    ds_read_b128 a[196:199], v21 offset:20480
    s_lshl_b32 s72, s69, 12
    s_add_u32 s72, s72, 1048576
    v_mfma_f32_32x32x16_bf16 v[144:159], v[180:183], a[24:27], v[144:159]
    ds_read_b64_tr_b16 v[172:173], v31 offset:18432
    ds_read_b64_tr_b16 v[174:175], v31 offset:18944
    buffer_load_dwordx4 v17, s[16:19], s74 offen offset:1024 lds
    ds_read_b64_tr_b16 v[198:199], v33 offset:16896
    s_lshl_b32 s44, s71, 17
    s_add_u32 s44, s44, s72
    s_waitcnt lgkmcnt(13)
    v_mfma_f32_32x32x16_bf16 v[128:143], v[184:187], a[28:31], v[128:143]
    ds_read_b64_tr_b16 v[176:177], v30 offset:20480
    ds_read_b64_tr_b16 v[178:179], v30 offset:20992
    buffer_load_dwordx4 v18, s[16:19], s74 offen offset:2048 lds
    ds_read_b128 a[200:203], v22 offset:20480
    s_add_u32 s45, s44, 0x20000
    s_add_u32 s46, s44, 0x40000
    v_mfma_f32_32x32x16_bf16 v[144:159], v[188:191], a[28:31], v[144:159]
    ds_read_b64_tr_b16 v[180:181], v31 offset:20480
    ds_read_b64_tr_b16 v[182:183], v31 offset:20992
    buffer_load_dwordx4 v19, s[16:19], s74 offen offset:3072 lds
    ds_read_b128 a[204:207], v23 offset:20480
    s_cmp_eq_u32 s67, 7
    s_cselect_b32 s45, 1073741824, s45
    s_cselect_b32 s46, 1073741824, s46
    s_lshr_b32 s71, s71, 1
    s_waitcnt lgkmcnt(6)
    v_dot2c_f32_bf16 v40, s55, v192
    v_dot2c_f32_bf16 v41, s55, v196
    v_dot2c_f32_bf16 v40, s55, v193
    v_dot2c_f32_bf16 v41, s55, v197
    v_dot2c_f32_bf16 v40, s55, v194
    v_dot2c_f32_bf16 v41, s55, v198
    v_dot2c_f32_bf16 v40, s55, v195
    v_dot2c_f32_bf16 v41, s55, v199
    s_barrier
    s_lshl_b32 s56, s60, 18
    s_lshl_b32 s73, s63, 11
    s_add_u32 s56, s56, s73
    s_add_u32 s56, s56, 1048576
    s_cmp_eq_u32 s61, 0
    s_cselect_b32 s56, 1073741824, s56
    s_waitcnt lgkmcnt(0)
    s_cbranch_scc1 Lnz_8
    s_waitcnt vmcnt(6)
    v_cmp_eq_u32 vcc, 0, v57
    v_xor_b32 v4, v98, v102
    v_xor_b32 v5, v106, v110
    v_cndmask_b32 v6, v114, v118, vcc
    v_or_b32 v4, v4, v5
    v_xor_b32 v5, v98, v106
    v_xor_b32 v6, v6, v114
    v_or3_b32 v4, v4, v5, v6
    v_xor_b32 v5, v98, v114
    v_xor_b32 v6, s53, v98
    v_or3_b32 v4, v4, v5, v6
    v_cmp_ne_u32 vcc, 0, v4
    s_nop 1
    s_and_b64 vcc, vcc, exec
    s_cbranch_scc1 Lre_7
Lok_6:
    v_pk_add_f32 v[96:97], v[96:97], v[100:101]
    v_pk_add_f32 v[104:105], v[104:105], v[108:109]
    v_pk_add_f32 v[112:113], v[112:113], v[116:117]
    v_pk_add_f32 v[96:97], v[96:97], v[104:105]
    v_pk_add_f32 v[96:97], v[96:97], v[112:113]
    s_nop 1
    v_permlane32_swap_b32 v96, v97
    v_add_f32 v97, v96, v97
    v_mov_b32 v96, v97
    s_nop 1
    v_permlane32_swap_b32 v96, v97
    v_mul_f32 v96, 0x3abe82fa, v96
    v_mul_f32 v97, 0x3abe82fa, v97
    v_fma_f32 v98, -v96, v96, v97
    v_max_f32 v98, 0, v98
    v_add_f32 v98, 0x3727c5ac, v98
    v_rsq_f32 v98, v98
    s_nop 0
    v_mul_f32 v100, v96, -v98
    v_pk_fma_f32 v[64:65], v[64:65], v[98:99], v[100:101] op_sel_hi:[1,0,0]
    v_pk_fma_f32 v[66:67], v[66:67], v[98:99], v[100:101] op_sel_hi:[1,0,0]
    v_cvt_pk_bf16_f32 v104, v64, v65
    v_cvt_pk_bf16_f32 v105, v66, v67
    ds_write_b64 v45, v[104:105] offset:0
    v_pk_fma_f32 v[68:69], v[68:69], v[98:99], v[100:101] op_sel_hi:[1,0,0]
    v_pk_fma_f32 v[70:71], v[70:71], v[98:99], v[100:101] op_sel_hi:[1,0,0]
    v_cvt_pk_bf16_f32 v106, v68, v69
    v_cvt_pk_bf16_f32 v107, v70, v71
    ds_write_b64 v47, v[106:107] offset:0
    v_pk_fma_f32 v[72:73], v[72:73], v[98:99], v[100:101] op_sel_hi:[1,0,0]
    v_pk_fma_f32 v[74:75], v[74:75], v[98:99], v[100:101] op_sel_hi:[1,0,0]
    v_cvt_pk_bf16_f32 v108, v72, v73
    v_cvt_pk_bf16_f32 v109, v74, v75
    ds_write_b64 v49, v[108:109] offset:0
    v_pk_fma_f32 v[76:77], v[76:77], v[98:99], v[100:101] op_sel_hi:[1,0,0]
    v_pk_fma_f32 v[78:79], v[78:79], v[98:99], v[100:101] op_sel_hi:[1,0,0]
    v_cvt_pk_bf16_f32 v110, v76, v77
    v_cvt_pk_bf16_f32 v111, v78, v79
    ds_write_b64 v51, v[110:111] offset:0
    ds_read_b64_tr_b16 v[208:209], v26 offset:0
    ds_read_b64_tr_b16 v[210:211], v27 offset:0
    ds_read_b64_tr_b16 v[212:213], v26 offset:1024
    ds_read_b64_tr_b16 v[214:215], v27 offset:1024
    v_pk_fma_f32 v[80:81], v[80:81], v[98:99], v[100:101] op_sel_hi:[1,0,0]
    v_pk_fma_f32 v[82:83], v[82:83], v[98:99], v[100:101] op_sel_hi:[1,0,0]
    v_cvt_pk_bf16_f32 v112, v80, v81
    v_cvt_pk_bf16_f32 v113, v82, v83
    ds_write_b64 v45, v[112:113] offset:2048
    v_pk_fma_f32 v[84:85], v[84:85], v[98:99], v[100:101] op_sel_hi:[1,0,0]
    v_pk_fma_f32 v[86:87], v[86:87], v[98:99], v[100:101] op_sel_hi:[1,0,0]
    v_cvt_pk_bf16_f32 v114, v84, v85
    v_cvt_pk_bf16_f32 v115, v86, v87
    ds_write_b64 v47, v[114:115] offset:2048
    v_pk_fma_f32 v[88:89], v[88:89], v[98:99], v[100:101] op_sel_hi:[1,0,0]
    v_pk_fma_f32 v[90:91], v[90:91], v[98:99], v[100:101] op_sel_hi:[1,0,0]
    v_cvt_pk_bf16_f32 v116, v88, v89
    v_cvt_pk_bf16_f32 v117, v90, v91
    ds_write_b64 v49, v[116:117] offset:2048
    s_waitcnt lgkmcnt(5)
    buffer_store_dwordx4 v[208:211], v0, s[20:23], s56 offen offset:0 sc1
    v_pk_fma_f32 v[92:93], v[92:93], v[98:99], v[100:101] op_sel_hi:[1,0,0]
    v_pk_fma_f32 v[94:95], v[94:95], v[98:99], v[100:101] op_sel_hi:[1,0,0]
    v_cvt_pk_bf16_f32 v118, v92, v93
    v_cvt_pk_bf16_f32 v119, v94, v95
    ds_write_b64 v51, v[118:119] offset:2048
    s_waitcnt lgkmcnt(4)
    buffer_store_dwordx4 v[212:215], v0, s[20:23], s56 offen offset:1024 sc1
    ds_read_b64_tr_b16 v[216:217], v26 offset:2048
    ds_read_b64_tr_b16 v[218:219], v27 offset:2048
    ds_read_b64_tr_b16 v[220:221], v26 offset:3072
    ds_read_b64_tr_b16 v[222:223], v27 offset:3072
    s_add_u32 s56, s56, 0x20000
    s_waitcnt lgkmcnt(2)
    buffer_store_dwordx4 v[216:219], v0, s[20:23], s56 offen offset:0 sc1
    s_waitcnt lgkmcnt(0)
    buffer_store_dwordx4 v[220:223], v0, s[20:23], s56 offen offset:1024 sc1
Lnz_8:
    v_mfma_f32_32x32x16_bf16 v[128:143], v[160:163], a[32:35], v[128:143]
    ds_read_b64_tr_b16 v[184:185], v30 offset:22528
    ds_read_b64_tr_b16 v[186:187], v30 offset:23040
    s_add_u32 s75, s52, 640
    ds_read_b64_tr_b16 v[192:193], v32 offset:24576
    v_bfe_u32 v8, v1, 1, 1
    s_and_b32 s75, s75, 0x3ff
    v_mfma_f32_32x32x16_bf16 v[144:159], v[164:167], a[32:35], v[144:159]
    ds_read_b64_tr_b16 v[188:189], v31 offset:22528
    ds_read_b64_tr_b16 v[190:191], v31 offset:23040
    s_mul_i32 s75, s75, s12
    ds_read_b64_tr_b16 v[194:195], v32 offset:25088
    v_add_u32 v8, s71, v8
    v_min_u32 v8, 10, v8
    s_add_u32 m0, s3, 139264
    s_add_u32 s75, s75, s57
    v_mfma_f32_32x32x16_bf16 v[128:143], v[168:171], a[36:39], v[128:143]
    ds_read_b64_tr_b16 v[160:161], v30 offset:24576
    ds_read_b64_tr_b16 v[162:163], v30 offset:25088
    buffer_load_dwordx4 v24, s[8:11], s75 offen offset:0 lds
    s_lshr_b32 s69, s40, 8
    v_mfma_f32_32x32x16_bf16 v[144:159], v[172:175], a[36:39], v[144:159]
    ds_read_b64_tr_b16 v[164:165], v31 offset:24576
    ds_read_b64_tr_b16 v[166:167], v31 offset:25088
    ds_read_b64_tr_b16 v[196:197], v33 offset:24576
    s_waitcnt vmcnt(26)
    ds_read_b128 a[208:211], v20 offset:24576
    v_lshrrev_b32 v9, 2, v1
    v_add_u32 v9, s69, v9
    v_mfma_f32_32x32x16_bf16 v[128:143], v[176:179], a[40:43], v[128:143]
    ds_read_b64_tr_b16 v[168:169], v30 offset:26624
    ds_read_b64_tr_b16 v[170:171], v30 offset:27136
    ds_read_b64_tr_b16 v[198:199], v33 offset:25088
    ds_read_b128 a[212:215], v21 offset:24576
    v_and_b32 v9, 7, v9
    v_lshl_add_u32 v8, v8, 4, v9
    v_mfma_f32_32x32x16_bf16 v[144:159], v[180:183], a[40:43], v[144:159]
    ds_read_b64_tr_b16 v[172:173], v31 offset:26624
    ds_read_b64_tr_b16 v[174:175], v31 offset:27136
    buffer_load_dwordx4 v25, s[8:11], s75 offen offset:1024 lds
    v_and_b32 v9, 1, v1
    v_lshlrev_b32 v9, 7, v9
    s_waitcnt lgkmcnt(13)
    v_mfma_f32_32x32x16_bf16 v[128:143], v[184:187], a[44:47], v[128:143]
    ds_read_b64_tr_b16 v[176:177], v30 offset:28672
    ds_read_b64_tr_b16 v[178:179], v30 offset:29184
    ds_read_b128 a[216:219], v22 offset:24576
    v_lshl_add_u32 v8, v8, 9, v9
    ds_read_b128 a[220:223], v23 offset:24576
    s_lshl_b32 s47, s68, 12
    v_mfma_f32_32x32x16_bf16 v[144:159], v[188:191], a[44:47], v[144:159]
    ds_read_b64_tr_b16 v[180:181], v31 offset:28672
    ds_read_b64_tr_b16 v[182:183], v31 offset:29184
    s_lshl_b32 s69, s70, 8
    s_add_u32 s47, s47, s69
    s_add_u32 s47, s47, 12582912
    s_waitcnt lgkmcnt(9)
    v_dot2c_f32_bf16 v40, s55, v192
    v_dot2c_f32_bf16 v41, s55, v196
    v_dot2c_f32_bf16 v40, s55, v193
    v_dot2c_f32_bf16 v41, s55, v197
    v_dot2c_f32_bf16 v40, s55, v194
    v_dot2c_f32_bf16 v41, s55, v198
    v_dot2c_f32_bf16 v40, s55, v195
    v_dot2c_f32_bf16 v41, s55, v199
    s_waitcnt vmcnt(6)
    s_barrier
    v_mfma_f32_32x32x16_bf16 v[128:143], v[160:163], a[48:51], v[128:143]
    ds_read_b64_tr_b16 v[184:185], v30 offset:30720
    ds_read_b64_tr_b16 v[186:187], v30 offset:31232
    s_add_u32 s74, s52, 768
    ds_read_b64_tr_b16 v[192:193], v32 offset:0
    v_lshl_add_u32 v56, v57, 30, v8
    s_and_b32 s74, s74, 0x3ff
    v_mfma_f32_32x32x16_bf16 v[144:159], v[164:167], a[48:51], v[144:159]
    ds_read_b64_tr_b16 v[188:189], v31 offset:30720
    ds_read_b64_tr_b16 v[190:191], v31 offset:31232
    s_mul_i32 s74, s74, s12
    ds_read_b64_tr_b16 v[194:195], v32 offset:512
    s_lshr_b32 s39, s78, 15
    s_mul_i32 s84, s67, 6
    s_add_u32 m0, s3, 147456
    s_add_u32 s74, s74, s57
    buffer_load_dwordx4 v24, s[8:11], s74 offen offset:0 lds
    s_waitcnt lgkmcnt(12)
    v_mfma_f32_32x32x16_bf16 v[128:143], v[168:171], a[52:55], v[128:143]
    ds_read_b64_tr_b16 v[160:161], v30 offset:0
    ds_read_b64_tr_b16 v[162:163], v30 offset:512
    buffer_load_dwordx4 v25, s[8:11], s74 offen offset:1024 lds
    s_add_u32 s84, s84, s68
    s_add_u32 m0, s54, 20480
    s_add_u32 s75, s81, 1280
    v_mfma_f32_32x32x16_bf16 v[144:159], v[172:175], a[52:55], v[144:159]
    ds_read_b64_tr_b16 v[164:165], v31 offset:0
    ds_read_b64_tr_b16 v[166:167], v31 offset:512
    buffer_load_dwordx4 v16, s[16:19], s75 offen offset:0 lds
    ds_read_b128 a[224:227], v20 offset:28672
    s_sub_u32 s84, s84, 1
    s_and_b32 s71, s48, 1
    s_waitcnt lgkmcnt(11)
    v_mfma_f32_32x32x16_bf16 v[128:143], v[176:179], a[56:59], v[128:143]
    ds_read_b64_tr_b16 v[168:169], v30 offset:2048
    ds_read_b64_tr_b16 v[170:171], v30 offset:2560
    ds_read_b64_tr_b16 v[196:197], v33 offset:0
    ds_read_b128 a[228:231], v21 offset:28672
    s_lshr_b32 s72, s48, 1
    s_lshl_b32 s68, s72, 14
    v_mfma_f32_32x32x16_bf16 v[144:159], v[180:183], a[56:59], v[144:159]
    ds_read_b64_tr_b16 v[172:173], v31 offset:2048
    ds_read_b64_tr_b16 v[174:175], v31 offset:2560
    buffer_load_dwordx4 v17, s[16:19], s75 offen offset:1024 lds
    ds_read_b64_tr_b16 v[198:199], v33 offset:512
    s_add_u32 s68, s68, 131072
    s_lshl_b32 s70, s71, 6
    s_waitcnt lgkmcnt(13)
    v_mfma_f32_32x32x16_bf16 v[128:143], v[184:187], a[60:63], v[128:143]
    ds_read_b64_tr_b16 v[176:177], v30 offset:4096
    ds_read_b64_tr_b16 v[178:179], v30 offset:4608
    buffer_load_dwordx4 v18, s[16:19], s75 offen offset:2048 lds
    ds_read_b128 a[232:235], v22 offset:28672
    v_and_b32 v8, 4, v1
    v_lshlrev_b32 v8, 2, v8
    v_mfma_f32_32x32x16_bf16 v[144:159], v[188:191], a[60:63], v[144:159]
    ds_read_b64_tr_b16 v[180:181], v31 offset:4096
    ds_read_b64_tr_b16 v[182:183], v31 offset:4608
    buffer_load_dwordx4 v19, s[16:19], s75 offen offset:3072 lds
    ds_read_b128 a[236:239], v23 offset:28672
    v_xor_b32 v8, s70, v8
    v_xor_b32 v8, v8, v34
    v_add_u32 v28, s68, v8
    s_waitcnt lgkmcnt(6)
    v_dot2c_f32_bf16 v40, s55, v192
    v_dot2c_f32_bf16 v41, s55, v196
    v_dot2c_f32_bf16 v40, s55, v193
    v_dot2c_f32_bf16 v41, s55, v197
    v_dot2c_f32_bf16 v40, s55, v194
    v_dot2c_f32_bf16 v41, s55, v198
    v_dot2c_f32_bf16 v40, s55, v195
    v_dot2c_f32_bf16 v41, s55, v199
    s_waitcnt vmcnt(6)
    s_barrier
    v_mfma_f32_32x32x16_bf16 v[128:143], v[160:163], a[64:67], v[128:143]
    ds_read_b64_tr_b16 v[184:185], v30 offset:6144
    ds_read_b64_tr_b16 v[186:187], v30 offset:6656
    s_lshl_b32 s80, s60, 6
    ds_read_b64_tr_b16 v[192:193], v32 offset:8192
    v_xor_b32 v29, 32, v28
    s_add_u32 s80, s80, s63
    v_mfma_f32_32x32x16_bf16 v[144:159], v[164:167], a[64:67], v[144:159]
    ds_read_b64_tr_b16 v[188:189], v31 offset:6144
    ds_read_b64_tr_b16 v[190:191], v31 offset:6656
    s_lshl_b32 s80, s80, 7
    ds_read_b64_tr_b16 v[194:195], v32 offset:8704
    v_add_u32 v29, 512, v29
    s_add_u32 s80, s80, 12582912
    s_cmp_eq_u32 s61, 0
    s_cselect_b32 s80, 1073741824, s80
    s_add_u32 s74, s52, 896
    s_and_b32 s74, s74, 0x3ff
    v_mfma_f32_32x32x16_bf16 v[128:143], v[168:171], a[68:71], v[128:143]
    ds_read_b64_tr_b16 v[160:161], v30 offset:8192
    ds_read_b64_tr_b16 v[162:163], v30 offset:8704
    s_waitcnt vmcnt(8)
    v_mov_b32 v14, s53
    buffer_store_dword v14, v61, s[20:23], s80 offen sc1
    s_lshl_b32 s70, s71, 5
    v_and_b32 v8, 16, v1
    v_mfma_f32_32x32x16_bf16 v[144:159], v[172:175], a[68:71], v[144:159]
    ds_read_b64_tr_b16 v[164:165], v31 offset:8192
    ds_read_b64_tr_b16 v[166:167], v31 offset:8704
    s_mul_i32 s74, s74, s12
    ds_read_b64_tr_b16 v[196:197], v33 offset:8192
    v_lshlrev_b32 v8, 1, v8
    v_xor_b32 v8, s70, v8
    s_add_u32 m0, s3, 155648
    s_add_u32 s74, s74, s57
    s_waitcnt lgkmcnt(12)
    v_mfma_f32_32x32x16_bf16 v[128:143], v[176:179], a[72:75], v[128:143]
    ds_read_b64_tr_b16 v[168:169], v30 offset:10240
    ds_read_b64_tr_b16 v[170:171], v30 offset:10752
    buffer_load_dwordx4 v24, s[8:11], s74 offen offset:0 lds
    s_lshl_b32 s72, s72, 11
    v_mfma_f32_32x32x16_bf16 v[144:159], v[180:183], a[72:75], v[144:159]
    ds_read_b64_tr_b16 v[172:173], v31 offset:10240
    ds_read_b64_tr_b16 v[174:175], v31 offset:10752
    buffer_load_dwordx4 v25, s[8:11], s74 offen offset:1024 lds
    ds_read_b64_tr_b16 v[198:199], v33 offset:8704
    s_sub_u32 s72, s72, s54
    v_xor_b32 v9, v8, v26
    s_waitcnt lgkmcnt(11)
    v_mfma_f32_32x32x16_bf16 v[128:143], v[184:187], a[76:79], v[128:143]
    ds_read_b64_tr_b16 v[176:177], v30 offset:12288
    ds_read_b64_tr_b16 v[178:179], v30 offset:12800
    v_add_u32 v36, s72, v9
    v_xor_b32 v9, v8, v27
    v_add_u32 v37, s72, v9
    v_mfma_f32_32x32x16_bf16 v[144:159], v[188:191], a[76:79], v[144:159]
    ds_read_b64_tr_b16 v[180:181], v31 offset:12288
    ds_read_b64_tr_b16 v[182:183], v31 offset:12800
    buffer_load_dwordx2 a[240:241], v62, s[4:7], s78 offen offset:0
    v_add_u32 v38, 0x10000, v36
    v_add_u32 v39, 0x10000, v37
    s_waitcnt lgkmcnt(4)
    v_dot2c_f32_bf16 v40, s55, v192
    v_dot2c_f32_bf16 v41, s55, v196
    v_dot2c_f32_bf16 v40, s55, v193
    v_dot2c_f32_bf16 v41, s55, v197
    v_dot2c_f32_bf16 v40, s55, v194
    v_dot2c_f32_bf16 v41, s55, v198
    v_dot2c_f32_bf16 v40, s55, v195
    v_dot2c_f32_bf16 v41, s55, v199
    s_waitcnt vmcnt(8)
    s_barrier
    v_mfma_f32_32x32x16_bf16 v[128:143], v[160:163], a[80:83], v[128:143]
    ds_read_b64_tr_b16 v[184:185], v30 offset:14336
    ds_read_b64_tr_b16 v[186:187], v30 offset:14848
    ds_read_b64_tr_b16 v[192:193], v32 offset:16384
    s_add_u32 m0, s54, 8192
    s_add_u32 s75, s85, 1280
    v_mfma_f32_32x32x16_bf16 v[144:159], v[164:167], a[80:83], v[144:159]
    ds_read_b64_tr_b16 v[188:189], v31 offset:14336
    ds_read_b64_tr_b16 v[190:191], v31 offset:14848
    buffer_load_dwordx4 v16, s[16:19], s75 offen offset:0 lds
    v_mfma_f32_32x32x16_bf16 v[128:143], v[168:171], a[84:87], v[128:143]
    ds_read_b64_tr_b16 v[160:161], v30 offset:16384
    ds_read_b64_tr_b16 v[162:163], v30 offset:16896
    buffer_load_dwordx4 v17, s[16:19], s75 offen offset:1024 lds
    ds_read_b64_tr_b16 v[194:195], v32 offset:16896
    v_mfma_f32_32x32x16_bf16 v[144:159], v[172:175], a[84:87], v[144:159]
    ds_read_b64_tr_b16 v[164:165], v31 offset:16384
    ds_read_b64_tr_b16 v[166:167], v31 offset:16896
    buffer_load_dwordx4 v18, s[16:19], s75 offen offset:2048 lds
    s_waitcnt lgkmcnt(10)
    v_mfma_f32_32x32x16_bf16 v[128:143], v[176:179], a[88:91], v[128:143]
    ds_read_b64_tr_b16 v[168:169], v30 offset:18432
    ds_read_b64_tr_b16 v[170:171], v30 offset:18944
    ds_read_b64_tr_b16 v[196:197], v33 offset:16384
    ds_read_b64_tr_b16 v[198:199], v33 offset:16896
    v_mfma_f32_32x32x16_bf16 v[144:159], v[180:183], a[88:91], v[144:159]
    ds_read_b64_tr_b16 v[172:173], v31 offset:18432
    ds_read_b64_tr_b16 v[174:175], v31 offset:18944
    buffer_load_dwordx4 v19, s[16:19], s75 offen offset:3072 lds
    s_waitcnt lgkmcnt(11)
    v_mfma_f32_32x32x16_bf16 v[128:143], v[184:187], a[92:95], v[128:143]
    ds_read_b64_tr_b16 v[176:177], v30 offset:20480
    ds_read_b64_tr_b16 v[178:179], v30 offset:20992
    v_mfma_f32_32x32x16_bf16 v[144:159], v[188:191], a[92:95], v[144:159]
    ds_read_b64_tr_b16 v[180:181], v31 offset:20480
    ds_read_b64_tr_b16 v[182:183], v31 offset:20992
    buffer_load_dwordx2 a[242:243], v62, s[4:7], s78 offen offset:16
    s_waitcnt lgkmcnt(6)
    v_dot2c_f32_bf16 v40, s55, v192
    v_dot2c_f32_bf16 v41, s55, v196
    v_dot2c_f32_bf16 v40, s55, v193
    v_dot2c_f32_bf16 v41, s55, v197
    v_dot2c_f32_bf16 v40, s55, v194
    v_dot2c_f32_bf16 v41, s55, v198
    v_dot2c_f32_bf16 v40, s55, v195
    v_dot2c_f32_bf16 v41, s55, v199
    s_waitcnt vmcnt(6)
    s_barrier
    v_mfma_f32_32x32x16_bf16 v[128:143], v[160:163], a[96:99], v[128:143]
    ds_read_b64_tr_b16 v[184:185], v30 offset:22528
    ds_read_b64_tr_b16 v[186:187], v30 offset:23040
    ds_read_b64_tr_b16 v[192:193], v32 offset:24576
    s_add_u32 m0, s54, 24576
    s_add_u32 s74, s81, 1536
    v_mfma_f32_32x32x16_bf16 v[144:159], v[164:167], a[96:99], v[144:159]
    ds_read_b64_tr_b16 v[188:189], v31 offset:22528
    ds_read_b64_tr_b16 v[190:191], v31 offset:23040
    buffer_load_dwordx4 v16, s[16:19], s74 offen offset:0 lds
    s_waitcnt lgkmcnt(9)
    v_mfma_f32_32x32x16_bf16 v[128:143], v[168:171], a[100:103], v[128:143]
    ds_read_b64_tr_b16 v[160:161], v30 offset:24576
    ds_read_b64_tr_b16 v[162:163], v30 offset:25088
    buffer_load_dwordx4 v17, s[16:19], s74 offen offset:1024 lds
    ds_read_b64_tr_b16 v[194:195], v32 offset:25088
    v_mfma_f32_32x32x16_bf16 v[144:159], v[172:175], a[100:103], v[144:159]
    ds_read_b64_tr_b16 v[164:165], v31 offset:24576
    ds_read_b64_tr_b16 v[166:167], v31 offset:25088
    buffer_load_dwordx4 v18, s[16:19], s74 offen offset:2048 lds
    s_waitcnt lgkmcnt(10)
    v_mfma_f32_32x32x16_bf16 v[128:143], v[176:179], a[104:107], v[128:143]
    ds_read_b64_tr_b16 v[168:169], v30 offset:26624
    ds_read_b64_tr_b16 v[170:171], v30 offset:27136
    ds_read_b64_tr_b16 v[196:197], v33 offset:24576
    ds_read_b64_tr_b16 v[198:199], v33 offset:25088
    v_mfma_f32_32x32x16_bf16 v[144:159], v[180:183], a[104:107], v[144:159]
    ds_read_b64_tr_b16 v[172:173], v31 offset:26624
    ds_read_b64_tr_b16 v[174:175], v31 offset:27136
    buffer_load_dwordx4 v19, s[16:19], s74 offen offset:3072 lds
    s_waitcnt lgkmcnt(11)
    v_mfma_f32_32x32x16_bf16 v[128:143], v[184:187], a[108:111], v[128:143]
    ds_read_b64_tr_b16 v[176:177], v30 offset:28672
    ds_read_b64_tr_b16 v[178:179], v30 offset:29184
    v_mfma_f32_32x32x16_bf16 v[144:159], v[188:191], a[108:111], v[144:159]
    ds_read_b64_tr_b16 v[180:181], v31 offset:28672
    ds_read_b64_tr_b16 v[182:183], v31 offset:29184
    buffer_load_dwordx2 a[244:245], v62, s[4:7], s78 offen offset:32
    s_waitcnt lgkmcnt(6)
    v_dot2c_f32_bf16 v40, s55, v192
    v_dot2c_f32_bf16 v41, s55, v196
    v_dot2c_f32_bf16 v40, s55, v193
    v_dot2c_f32_bf16 v41, s55, v197
    v_dot2c_f32_bf16 v40, s55, v194
    v_dot2c_f32_bf16 v41, s55, v198
    v_dot2c_f32_bf16 v40, s55, v195
    v_dot2c_f32_bf16 v41, s55, v199
    s_nop 2
    ds_write_b32 v42, v40
    ds_write_b32 v42, v41 offset:1024
    s_waitcnt lgkmcnt(0)
    s_barrier
    v_mfma_f32_32x32x16_bf16 v[128:143], v[160:163], a[112:115], v[128:143]
    ds_read_b64_tr_b16 v[184:185], v30 offset:30720
    ds_read_b64_tr_b16 v[186:187], v30 offset:31232
    buffer_load_dword v59, v56, s[20:23], s47 offen sc1
    v_mfma_f32_32x32x16_bf16 v[144:159], v[164:167], a[112:115], v[144:159]
    ds_read_b64_tr_b16 v[188:189], v31 offset:30720
    ds_read_b64_tr_b16 v[190:191], v31 offset:31232
    buffer_load_dword v15, v61, s[20:23], s83 offen sc1
    ds_read_b128 v[208:211], v43 offset:0
    ds_read_b128 v[212:215], v43 offset:16
    ds_read_b128 v[216:219], v43 offset:1024
    ds_read_b128 v[220:223], v43 offset:1040
    s_nop 0
    v_mfma_f32_32x32x16_bf16 v[128:143], v[168:171], a[116:119], v[128:143]
    s_nop 0
    s_add_u32 m0, s54, 28672
    s_waitcnt lgkmcnt(0)
    s_add_u32 s75, s85, 1536
    v_add_f32 v208, v208, v209
    v_add_f32 v208, v208, v210
    v_mfma_f32_32x32x16_bf16 v[144:159], v[172:175], a[116:119], v[144:159]
    buffer_load_dwordx4 v16, s[16:19], s75 offen offset:0 lds
    v_add_f32 v208, v208, v211
    v_add_f32 v208, v208, v212
    v_add_f32 v208, v208, v213
    v_add_f32 v208, v208, v214
    v_mfma_f32_32x32x16_bf16 v[128:143], v[176:179], a[120:123], v[128:143]
    buffer_load_dwordx4 v17, s[16:19], s75 offen offset:1024 lds
    v_add_f32 v208, v208, v215
    v_cvt_pk_bf16_f32 v212, v208, v208
    v_and_b32 v213, 0xffff0000, v212
    v_sub_f32 v213, v208, v213
    v_mfma_f32_32x32x16_bf16 v[144:159], v[180:183], a[120:123], v[144:159]
    buffer_load_dwordx4 v18, s[16:19], s75 offen offset:2048 lds
    v_cvt_pk_bf16_f32 v213, v213, v213
    v_mov_b32 v214, 0
    v_mov_b32 v215, 0
    v_add_f32 v216, v216, v217
    v_mfma_f32_32x32x16_bf16 v[128:143], v[184:187], a[124:127], v[128:143]
    buffer_load_dwordx4 v19, s[16:19], s75 offen offset:3072 lds
    v_add_f32 v216, v216, v218
    v_add_f32 v216, v216, v219
    v_add_f32 v216, v216, v220
    v_add_f32 v216, v216, v221
    v_mfma_f32_32x32x16_bf16 v[144:159], v[188:191], a[124:127], v[144:159]
    buffer_load_dwordx2 a[246:247], v62, s[4:7], s78 offen offset:48
    v_add_f32 v216, v216, v222
    v_add_f32 v216, v216, v223
    v_cvt_pk_bf16_f32 v220, v216, v216
    v_and_b32 v221, 0xffff0000, v220
    v_sub_f32 v221, v216, v221
    v_cvt_pk_bf16_f32 v221, v221, v221
    v_mov_b32 v222, 0
    v_mov_b32 v223, 0
    s_nop 1
    v_mfma_f32_32x32x16_bf16 v[128:143], v[212:215], v[52:55], v[128:143]
    v_mfma_f32_32x32x16_bf16 v[144:159], v[220:223], v[52:55], v[144:159]
    s_barrier
    s_cmp_eq_u32 s51, 0
    s_cbranch_scc1 LY_9
    s_mov_b32 s64, s83
    s_lshl_b32 s83, s50, 6
    s_add_u32 s83, s83, s63
    s_lshl_b32 s83, s83, 7
    s_add_u32 s83, s83, 12779520
    v_xor_b32 v2, 0, v63
    ds_write_b128 v2, v[224:227] offset:0
    v_xor_b32 v3, 16, v63
    ds_write_b128 v3, v[228:231] offset:0
    v_xor_b32 v4, 32, v63
    ds_write_b128 v4, v[232:235] offset:0
    v_xor_b32 v5, 48, v63
    ds_write_b128 v5, v[236:239] offset:0
    ds_read_b128 a[0:3], v20 offset:0
    ds_read_b128 a[4:7], v21 offset:0
    ds_read_b128 a[8:11], v22 offset:0
    ds_read_b128 a[12:15], v23 offset:0
    ds_read_b128 a[16:19], v20 offset:4096
    ds_read_b128 a[20:23], v21 offset:4096
    ds_read_b128 a[24:27], v22 offset:4096
    ds_read_b128 a[28:31], v23 offset:4096
    s_waitcnt vmcnt(6)
    v_cmp_eq_u32 vcc, s53, v59
    s_nop 1
    s_mov_b32 s76, vcc_lo
    s_andn2_b32 s68, 15, s76
    s_cbranch_scc1 Ls_11
Lb_12:
    s_add_u32 s8, s44, 0
    s_add_u32 s9, s45, 0
    s_add_u32 s10, s46, 0
    buffer_load_dwordx4 v[64:67], v35, s[20:23], s8 offen offset:0 sc1
    ds_write_b128 v2, v[240:243] offset:16384
    ds_write_b128 v3, v[244:247] offset:16384
    ds_write_b128 v4, v[248:251] offset:16384
    ds_write_b128 v5, v[252:255] offset:16384
    buffer_load_dwordx4 v[68:71], v35, s[20:23], s9 offen offset:0 sc1
    v_pk_mul_f32 v[128:129], v[128:129], v[50:51] op_sel_hi:[1,0]
    v_pk_mul_f32 v[130:131], v[130:131], v[50:51] op_sel_hi:[1,0]
    v_pk_mul_f32 v[132:133], v[132:133], v[50:51] op_sel_hi:[1,0]
    v_pk_mul_f32 v[134:135], v[134:135], v[50:51] op_sel_hi:[1,0]
    v_pk_mul_f32 v[136:137], v[136:137], v[50:51] op_sel_hi:[1,0]
    v_pk_mul_f32 v[138:139], v[138:139], v[50:51] op_sel_hi:[1,0]
    v_pk_mul_f32 v[140:141], v[140:141], v[50:51] op_sel_hi:[1,0]
    v_pk_mul_f32 v[142:143], v[142:143], v[50:51] op_sel_hi:[1,0]
    v_pk_mul_f32 v[144:145], v[144:145], v[50:51] op_sel_hi:[1,0]
    v_pk_mul_f32 v[146:147], v[146:147], v[50:51] op_sel_hi:[1,0]
    buffer_load_dwordx4 v[72:75], v35, s[20:23], s10 offen offset:0 sc1
    v_pk_mul_f32 v[148:149], v[148:149], v[50:51] op_sel_hi:[1,0]
    v_pk_mul_f32 v[150:151], v[150:151], v[50:51] op_sel_hi:[1,0]
    v_pk_mul_f32 v[152:153], v[152:153], v[50:51] op_sel_hi:[1,0]
    v_pk_mul_f32 v[154:155], v[154:155], v[50:51] op_sel_hi:[1,0]
    v_pk_mul_f32 v[156:157], v[156:157], v[50:51] op_sel_hi:[1,0]
    v_pk_mul_f32 v[158:159], v[158:159], v[50:51] op_sel_hi:[1,0]
    v_cvt_pk_bf16_f32 v128, v128, v129
    v_cvt_pk_bf16_f32 v129, v130, v131
    ds_write_b64 v45, v[128:129] offset:0
    v_cvt_pk_bf16_f32 v130, v132, v133
    v_cvt_pk_bf16_f32 v131, v134, v135
    buffer_load_dwordx4 v[76:79], v35, s[20:23], s8 offen offset:1024 sc1
    ds_write_b64 v47, v[130:131] offset:0
    v_cvt_pk_bf16_f32 v132, v136, v137
    v_cvt_pk_bf16_f32 v133, v138, v139
    ds_write_b64 v49, v[132:133] offset:0
    v_cvt_pk_bf16_f32 v134, v140, v141
    v_cvt_pk_bf16_f32 v135, v142, v143
    ds_write_b64 v51, v[134:135] offset:0
    v_cvt_pk_bf16_f32 v136, v144, v145
    v_cvt_pk_bf16_f32 v137, v146, v147
    ds_write_b64 v45, v[136:137] offset:2048
    v_cvt_pk_bf16_f32 v138, v148, v149
    v_cvt_pk_bf16_f32 v139, v150, v151
    ds_write_b64 v47, v[138:139] offset:2048
    v_cvt_pk_bf16_f32 v140, v152, v153
    v_cvt_pk_bf16_f32 v141, v154, v155
    buffer_load_dwordx4 v[80:83], v35, s[20:23], s9 offen offset:1024 sc1
    ds_write_b64 v49, v[140:141] offset:2048
    v_cvt_pk_bf16_f32 v142, v156, v157
    v_cvt_pk_bf16_f32 v143, v158, v159
    ds_write_b64 v51, v[142:143] offset:2048
    v_and_b32 v10, 16, v1
    v_cmp_ne_u32 s[70:71], 0, v10
    v_mov_b32 v11, s55
    v_and_b32 v42, 31, v1
    v_lshlrev_b32 v42, 2, v42
    v_lshl_add_u32 v43, v57, 30, v42
    v_lshl_add_u32 v42, v57, 9, v42
    s_lshl_b32 s69, s50, 2
    s_add_u32 s69, s69, s48
    s_mul_i32 s69, s69, 2176
    s_add_u32 s69, s69, 65536
    s_waitcnt lgkmcnt(0)
    s_barrier
    ds_read_b64_tr_b16 v[160:161], v36 offset:0
    ds_read_b64_tr_b16 v[162:163], v37 offset:0
    ds_read_b64_tr_b16 v[192:193], v28 offset:0
    ds_read_b64_tr_b16 v[194:195], v29 offset:0
    ds_read_b64_tr_b16 v[164:165], v36 offset:1024
    ds_read_b64_tr_b16 v[166:167], v37 offset:1024
    ds_read_b64_tr_b16 v[196:197], v28 offset:2048
    ds_read_b64_tr_b16 v[198:199], v29 offset:2048
    ds_read_b64_tr_b16 v[168:169], v36 offset:32768
    ds_read_b64_tr_b16 v[170:171], v37 offset:32768
    ds_read_b64_tr_b16 v[200:201], v28 offset:4096
    ds_read_b64_tr_b16 v[202:203], v29 offset:4096
    ds_read_b64_tr_b16 v[172:173], v36 offset:33792
    ds_read_b64_tr_b16 v[174:175], v37 offset:33792
    ds_read_b64_tr_b16 v[204:205], v28 offset:6144
    ds_read_b64_tr_b16 v[206:207], v29 offset:6144
    buffer_load_dwordx4 v[84:87], v35, s[20:23], s10 offen offset:1024 sc1
    ds_read_b64_tr_b16 v[176:177], v38 offset:0
    ds_read_b64_tr_b16 v[178:179], v39 offset:0
    ds_read_b64_tr_b16 v[208:209], v28 offset:8192
    ds_read_b64_tr_b16 v[210:211], v29 offset:8192
    ds_read_b64_tr_b16 v[180:181], v38 offset:1024
    ds_read_b64_tr_b16 v[182:183], v39 offset:1024
    ds_read_b64_tr_b16 v[212:213], v28 offset:10240
    ds_read_b64_tr_b16 v[214:215], v29 offset:10240
    ds_read_b64_tr_b16 v[184:185], v38 offset:32768
    ds_read_b64_tr_b16 v[186:187], v39 offset:32768
    ds_read_b64_tr_b16 v[216:217], v28 offset:12288
    ds_read_b64_tr_b16 v[218:219], v29 offset:12288
    ds_read_b64_tr_b16 v[188:189], v38 offset:33792
    ds_read_b64_tr_b16 v[190:191], v39 offset:33792
    ds_read_b64_tr_b16 v[220:221], v28 offset:14336
    ds_read_b64_tr_b16 v[222:223], v29 offset:14336
    buffer_load_dwordx4 v[88:91], v35, s[20:23], s8 offen offset:2048 sc1
    s_waitcnt lgkmcnt(15)
    v_cndmask_b32 v160, v160, v11, s[70:71]
    v_cndmask_b32 v161, v161, v11, s[70:71]
    v_cndmask_b32 v162, v162, v11, s[70:71]
    v_cndmask_b32 v163, v163, v11, s[70:71]
    s_nop 1
    v_mfma_f32_32x32x16_bf16 v[224:239], v[160:163], v[192:195], 0
    v_cndmask_b32 v164, v164, v11, s[70:71]
    v_cndmask_b32 v165, v165, v11, s[70:71]
    v_cndmask_b32 v166, v166, v11, s[70:71]
    v_cndmask_b32 v167, v167, v11, s[70:71]
    buffer_load_dwordx4 v[92:95], v35, s[20:23], s9 offen offset:2048 sc1
    s_nop 1
    v_mfma_f32_32x32x16_bf16 v[224:239], v[164:167], v[196:199], v[224:239]
    v_cndmask_b32 v168, v168, v11, s[70:71]
    v_cndmask_b32 v169, v169, v11, s[70:71]
    v_cndmask_b32 v170, v170, v11, s[70:71]
    v_cndmask_b32 v171, v171, v11, s[70:71]
    s_nop 1
    v_mfma_f32_32x32x16_bf16 v[224:239], v[168:171], v[200:203], v[224:239]
    v_cndmask_b32 v172, v172, v11, s[70:71]
    v_cndmask_b32 v173, v173, v11, s[70:71]
    v_cndmask_b32 v174, v174, v11, s[70:71]
    v_cndmask_b32 v175, v175, v11, s[70:71]
    buffer_load_dwordx4 v[96:99], v35, s[20:23], s10 offen offset:2048 sc1
    s_nop 1
    v_mfma_f32_32x32x16_bf16 v[224:239], v[172:175], v[204:207], v[224:239]
    s_waitcnt lgkmcnt(12)
    v_cndmask_b32 v176, v176, v11, s[70:71]
    v_cndmask_b32 v177, v177, v11, s[70:71]
    v_cndmask_b32 v178, v178, v11, s[70:71]
    v_cndmask_b32 v179, v179, v11, s[70:71]
    s_nop 1
    v_mfma_f32_32x32x16_bf16 v[224:239], v[176:179], v[208:211], v[224:239]
    s_waitcnt lgkmcnt(8)
    v_cndmask_b32 v180, v180, v11, s[70:71]
    v_cndmask_b32 v181, v181, v11, s[70:71]
    v_cndmask_b32 v182, v182, v11, s[70:71]
    v_cndmask_b32 v183, v183, v11, s[70:71]
    buffer_load_dwordx4 v[100:103], v35, s[20:23], s8 offen offset:3072 sc1
    s_nop 1
    v_mfma_f32_32x32x16_bf16 v[224:239], v[180:183], v[212:215], v[224:239]
    s_waitcnt lgkmcnt(4)
    v_cndmask_b32 v184, v184, v11, s[70:71]
    v_cndmask_b32 v185, v185, v11, s[70:71]
    v_cndmask_b32 v186, v186, v11, s[70:71]
    v_cndmask_b32 v187, v187, v11, s[70:71]
    s_nop 1
    v_mfma_f32_32x32x16_bf16 v[224:239], v[184:187], v[216:219], v[224:239]
    s_waitcnt lgkmcnt(0)
    v_cndmask_b32 v188, v188, v11, s[70:71]
    v_cndmask_b32 v189, v189, v11, s[70:71]
    v_cndmask_b32 v190, v190, v11, s[70:71]
    v_cndmask_b32 v191, v191, v11, s[70:71]
    buffer_load_dwordx4 v[104:107], v35, s[20:23], s9 offen offset:3072 sc1
    s_nop 1
    v_mfma_f32_32x32x16_bf16 v[224:239], v[188:191], v[220:223], v[224:239]
    buffer_load_dwordx4 v[108:111], v35, s[20:23], s10 offen offset:3072 sc1
    s_andn2_b32 s68, 240, s76
    s_cbranch_scc1 Ls_13
Lb_14:
    s_add_u32 s36, s44, 8192
    s_add_u32 s37, s45, 8192
    s_add_u32 s38, s46, 8192
    buffer_load_dwordx4 v[112:115], v35, s[20:23], s36 offen offset:0 sc1
    buffer_load_dwordx4 v[116:119], v35, s[20:23], s37 offen offset:0 sc1
    s_add_u32 m0, s54, 0
    s_add_u32 s74, s81, 1792
    buffer_load_dwordx4 v16, s[16:19], s74 offen offset:0 lds
    buffer_load_dwordx4 v17, s[16:19], s74 offen offset:1024 lds
    buffer_load_dwordx4 v18, s[16:19], s74 offen offset:2048 lds
    buffer_load_dwordx4 v19, s[16:19], s74 offen offset:3072 lds
    s_add_u32 m0, s54, 4096
    s_add_u32 s75, s85, 1792
    buffer_load_dwordx4 v16, s[16:19], s75 offen offset:0 lds
    buffer_load_dwordx4 v17, s[16:19], s75 offen offset:1024 lds
    buffer_load_dwordx4 v18, s[16:19], s75 offen offset:2048 lds
    buffer_load_dwordx4 v19, s[16:19], s75 offen offset:3072 lds
    s_waitcnt vmcnt(27)
    v_cmp_ne_u32 vcc, s53, v15
    s_nop 1
    s_and_b32 s68, vcc_lo, 1
    s_cbranch_scc1 Ls_15
Lb_16:
    s_waitcnt vmcnt(21)
    v_mfma_f32_32x32x16_bf16 a[32:47], v[64:67], a[128:131], 0
    buffer_load_dwordx4 v[120:123], v35, s[20:23], s38 offen offset:0 sc1
    v_mfma_f32_32x32x16_bf16 a[48:63], v[64:67], a[144:147], 0
    buffer_atomic_add_f32 v224, v42, s[20:23], s69 offen offset:0
    s_waitcnt vmcnt(22)
    v_mfma_f32_32x32x16_bf16 a[64:79], v[68:71], a[128:131], 0
    buffer_load_dwordx4 v[124:127], v35, s[20:23], s36 offen offset:1024 sc1
    v_mfma_f32_32x32x16_bf16 a[80:95], v[68:71], a[144:147], 0
    buffer_atomic_add_f32 v225, v42, s[20:23], s69 offen offset:128
    s_waitcnt vmcnt(23)
    v_mfma_f32_32x32x16_bf16 a[96:111], v[72:75], a[128:131], 0
    buffer_load_dwordx4 v[64:67], v35, s[20:23], s37 offen offset:1024 sc1
    buffer_atomic_add_f32 v226, v42, s[20:23], s69 offen offset:256
    v_mfma_f32_32x32x16_bf16 a[112:127], v[72:75], a[144:147], 0
    buffer_atomic_add_f32 v227, v42, s[20:23], s69 offen offset:384
    s_waitcnt vmcnt(25)
    v_mfma_f32_32x32x16_bf16 a[32:47], v[76:79], a[132:135], a[32:47]
    buffer_load_dwordx4 v[68:71], v35, s[20:23], s38 offen offset:1024 sc1
    buffer_atomic_add_f32 v228, v42, s[20:23], s69 offen offset:1024
    v_mfma_f32_32x32x16_bf16 a[48:63], v[76:79], a[148:151], a[48:63]
    buffer_atomic_add_f32 v229, v42, s[20:23], s69 offen offset:1152
    s_waitcnt vmcnt(27)
    v_mfma_f32_32x32x16_bf16 a[64:79], v[80:83], a[132:135], a[64:79]
    buffer_load_dwordx4 v[72:75], v35, s[20:23], s36 offen offset:2048 sc1
    buffer_atomic_add_f32 v230, v42, s[20:23], s69 offen offset:1280
    v_mfma_f32_32x32x16_bf16 a[80:95], v[80:83], a[148:151], a[80:95]
    buffer_atomic_add_f32 v231, v42, s[20:23], s69 offen offset:1408
    s_waitcnt vmcnt(29)
    v_mfma_f32_32x32x16_bf16 a[96:111], v[84:87], a[132:135], a[96:111]
    buffer_load_dwordx4 v[76:79], v35, s[20:23], s37 offen offset:2048 sc1
    buffer_atomic_add_f32 v232, v43, s[20:23], s69 offen offset:2048
    v_mfma_f32_32x32x16_bf16 a[112:127], v[84:87], a[148:151], a[112:127]
    s_waitcnt vmcnt(30)
    v_mfma_f32_32x32x16_bf16 a[32:47], v[88:91], a[136:139], a[32:47]
    buffer_load_dwordx4 v[80:83], v35, s[20:23], s38 offen offset:2048 sc1
    v_mfma_f32_32x32x16_bf16 a[48:63], v[88:91], a[152:155], a[48:63]
    s_waitcnt vmcnt(30)
    v_mfma_f32_32x32x16_bf16 a[64:79], v[92:95], a[136:139], a[64:79]
    buffer_load_dwordx4 v[84:87], v35, s[20:23], s36 offen offset:3072 sc1
    v_mfma_f32_32x32x16_bf16 a[80:95], v[92:95], a[152:155], a[80:95]
    s_waitcnt vmcnt(30)
    v_mfma_f32_32x32x16_bf16 a[96:111], v[96:99], a[136:139], a[96:111]
    buffer_load_dwordx4 v[88:91], v35, s[20:23], s37 offen offset:3072 sc1
    v_lshrrev_b32 v2, 3, v1
    v_mfma_f32_32x32x16_bf16 a[112:127], v[96:99], a[152:155], a[112:127]
    v_bfe_u32 v3, v1, 4, 1
    v_lshlrev_b32 v3, 2, v3
    v_and_b32 v4, 7, v1
    s_waitcnt vmcnt(30)
    v_mfma_f32_32x32x16_bf16 a[32:47], v[100:103], a[140:143], a[32:47]
    buffer_load_dwordx4 v[92:95], v35, s[20:23], s38 offen offset:3072 sc1
    v_xor_b32 v3, v3, v4
    v_mfma_f32_32x32x16_bf16 a[48:63], v[100:103], a[156:159], a[48:63]
    v_lshlrev_b32 v3, 4, v3
    v_lshl_add_u32 v16, v2, 10, v3
    v_add_u32 v17, 7168, v16
    s_waitcnt vmcnt(30)
    v_mfma_f32_32x32x16_bf16 a[64:79], v[104:107], a[140:143], a[64:79]
    s_andn2_b32 s68, 3840, s76
    s_cbranch_scc1 Ls_17
Lb_18:
    s_add_u32 s8, s44, 16384
    s_add_u32 s9, s45, 16384
    s_add_u32 s10, s46, 16384
    buffer_load_dwordx4 v[96:99], v35, s[20:23], s8 offen offset:0 sc1
    v_mfma_f32_32x32x16_bf16 a[80:95], v[104:107], a[156:159], a[80:95]
    v_add_u32 v18, 14336, v16
    v_add_u32 v19, 21504, v16
    s_lshr_b32 s12, s48, 1
    s_and_b32 s13, s48, 1
    s_waitcnt vmcnt(30)
    v_mfma_f32_32x32x16_bf16 a[96:111], v[108:111], a[140:143], a[96:111]
    buffer_load_dwordx4 v[100:103], v35, s[20:23], s9 offen offset:0 sc1
    s_lshl_b32 s14, s67, 7
    v_mfma_f32_32x32x16_bf16 a[112:127], v[108:111], a[156:159], a[112:127]
    s_lshl_b32 s72, s12, 18
    s_add_u32 s15, s72, s14
    s_mul_i32 s72, s12, 360448
    s_waitcnt vmcnt(30)
    v_mfma_f32_32x32x16_bf16 a[32:47], v[112:115], a[160:163], a[32:47]
    buffer_load_dwordx4 v[104:107], v35, s[20:23], s10 offen offset:0 sc1
    s_add_u32 s75, s72, s14
    v_mfma_f32_32x32x16_bf16 a[48:63], v[112:115], a[176:179], a[48:63]
    s_lshl_b32 s72, s13, 16
    s_add_u32 s15, s15, s72
    s_add_u32 s4, s75, s72
    s_waitcnt vmcnt(30)
    v_mfma_f32_32x32x16_bf16 a[64:79], v[116:119], a[160:163], a[64:79]
    buffer_load_dwordx4 v[108:111], v35, s[20:23], s8 offen offset:1024 sc1
    s_add_u32 s75, s4, s72
    v_mfma_f32_32x32x16_bf16 a[80:95], v[116:119], a[176:179], a[80:95]
    s_lshl_b32 s7, s39, 15
    s_lshl_b32 s72, s12, 14
    s_add_u32 s7, s7, s72
    s_waitcnt vmcnt(22)
    v_mfma_f32_32x32x16_bf16 a[96:111], v[120:123], a[160:163], a[96:111]
    buffer_load_dwordx4 v[112:115], v35, s[20:23], s9 offen offset:1024 sc1
    s_add_u32 s7, s7, 10485760
    v_mfma_f32_32x32x16_bf16 a[112:127], v[120:123], a[176:179], a[112:127]
    s_mul_i32 s41, s39, 45056
    s_mul_i32 s72, s12, 22528
    s_add_u32 s41, s41, s72
    s_waitcnt vmcnt(21)
    v_mfma_f32_32x32x16_bf16 a[32:47], v[124:127], a[164:167], a[32:47]
    buffer_load_dwordx4 v[116:119], v35, s[20:23], s10 offen offset:1024 sc1
    s_add_u32 s41, s41, 7340032
    v_mfma_f32_32x32x16_bf16 a[48:63], v[124:127], a[180:183], a[48:63]
    s_lshl_b32 s79, s48, 13
    v_accvgpr_read_b32 v32, a248
    v_add_u32 v6, s54, v0
    s_waitcnt vmcnt(20)
    v_mfma_f32_32x32x16_bf16 a[64:79], v[64:67], a[164:167], a[64:79]
    buffer_load_dwordx4 v[120:123], v35, s[20:23], s8 offen offset:2048 sc1
    v_lshlrev_b32 v32, 16, v32
    v_mfma_f32_32x32x16_bf16 a[80:95], v[64:67], a[180:183], a[80:95]
    v_xor_b32 v7, 32768, v6
    v_xor_b32 v8, 65536, v6
    v_xor_b32 v9, 98304, v6
    s_waitcnt vmcnt(18)
    v_mfma_f32_32x32x16_bf16 a[96:111], v[68:71], a[164:167], a[96:111]
    buffer_load_dwordx4 v[124:127], v35, s[20:23], s9 offen offset:2048 sc1
    v_bfe_u32 v2, v1, 2, 2
    v_mfma_f32_32x32x16_bf16 a[112:127], v[68:71], a[180:183], a[112:127]
    v_lshlrev_b32 v2, 7, v2
    v_bfe_u32 v3, v1, 3, 1
    v_xor_b32 v3, s12, v3
    s_waitcnt vmcnt(16)
    v_mfma_f32_32x32x16_bf16 a[32:47], v[72:75], a[168:171], a[32:47]
    buffer_load_dwordx4 v[64:67], v35, s[20:23], s10 offen offset:2048 sc1
    v_lshl_add_u32 v2, v3, 6, v2
    v_mfma_f32_32x32x16_bf16 a[48:63], v[72:75], a[184:187], a[48:63]
    s_waitcnt vmcnt(13)
    v_mov_b32 v14, s53
    buffer_store_dword v14, v61, s[20:23], s83 offen sc1
    v_mfma_f32_32x32x16_bf16 a[64:79], v[76:79], a[168:171], a[64:79]
    buffer_load_dwordx4 v[68:71], v35, s[20:23], s8 offen offset:3072 sc1
    v_bfe_u32 v3, v1, 4, 1
    v_lshl_add_u32 v2, v3, 5, v2
    v_mfma_f32_32x32x16_bf16 a[80:95], v[76:79], a[184:187], a[80:95]
    v_and_b32 v3, 3, v1
    v_lshl_add_u32 v2, v3, 3, v2
    s_lshl_b32 s72, s12, 16
    v_lshl_add_u32 v3, v57, 11, v2
    v_add_u32 v36, s72, v3
    s_waitcnt vmcnt(14)
    v_mfma_f32_32x32x16_bf16 a[96:111], v[80:83], a[168:171], a[96:111]
    buffer_load_dwordx4 v[72:75], v35, s[20:23], s9 offen offset:3072 sc1
    v_xor_b32 v37, 64, v36
    v_mfma_f32_32x32x16_bf16 a[112:127], v[80:83], a[184:187], a[112:127]
    v_lshl_add_u32 v3, v57, 9, v2
    v_add_u32 v28, s72, v3
    v_xor_b32 v29, 64, v28
    s_waitcnt vmcnt(14)
    v_mfma_f32_32x32x16_bf16 a[32:47], v[84:87], a[172:175], a[32:47]
    buffer_load_dwordx4 v[76:79], v35, s[20:23], s10 offen offset:3072 sc1
    s_lshl_b32 s72, s12, 14
    v_mfma_f32_32x32x16_bf16 a[48:63], v[84:87], a[188:191], a[48:63]
    s_add_u32 s72, s72, 131072
    v_add_u32 v38, s72, v3
    v_xor_b32 v39, 64, v38
    s_waitcnt vmcnt(14)
    v_mfma_f32_32x32x16_bf16 a[64:79], v[88:91], a[172:175], a[64:79]
    s_andn2_b32 s68, 61440, s76
    s_cbranch_scc1 Ls_19
Lb_20:
    s_add_u32 s36, s44, 24576
    s_add_u32 s37, s45, 24576
    s_add_u32 s38, s46, 24576
    buffer_load_dwordx4 v[80:83], v35, s[20:23], s36 offen offset:0 sc1
    v_mfma_f32_32x32x16_bf16 a[80:95], v[88:91], a[188:191], a[80:95]
    v_and_b32 v41, 3, v1
    v_lshlrev_b32 v41, 7, v41
    s_lshl_b32 s5, s39, 10
    s_lshl_b32 s72, s12, 9
    s_waitcnt vmcnt(14)
    v_mfma_f32_32x32x16_bf16 a[96:111], v[92:95], a[172:175], a[96:111]
    buffer_load_dwordx4 v[84:87], v35, s[20:23], s37 offen offset:0 sc1
    s_add_u32 s5, s5, s72
    v_mfma_f32_32x32x16_bf16 a[112:127], v[92:95], a[188:191], a[112:127]
    s_add_u32 s5, s5, 12845056
    s_lshl_b32 s82, s66, 12
    s_add_u32 s82, s82, 12976128
    s_waitcnt vmcnt(14)
    v_mfma_f32_32x32x16_bf16 a[32:47], v[96:99], a[192:195], a[32:47]
    buffer_load_dwordx4 v[88:91], v35, s[20:23], s38 offen offset:0 sc1
    s_lshl_b32 s72, s67, 2
    v_mfma_f32_32x32x16_bf16 a[48:63], v[96:99], a[208:211], a[48:63]
    s_add_u32 s72, s72, s48
    s_lshl_b32 s72, s72, 7
    s_add_u32 s6, s82, s72
    s_waitcnt vmcnt(14)
    v_mfma_f32_32x32x16_bf16 a[64:79], v[100:103], a[192:195], a[64:79]
    buffer_load_dwordx4 v[92:95], v35, s[20:23], s36 offen offset:1024 sc1
    s_lshl_b32 s72, s13, 7
    v_mfma_f32_32x32x16_bf16 a[80:95], v[100:103], a[208:211], a[80:95]
    s_add_u32 s82, s82, s72
    v_and_b32 v40, 15, v1
    v_lshlrev_b32 v40, 8, v40
    s_waitcnt vmcnt(14)
    v_mfma_f32_32x32x16_bf16 a[96:111], v[104:107], a[192:195], a[96:111]
    buffer_load_dwordx4 v[96:99], v35, s[20:23], s37 offen offset:1024 sc1
    v_mfma_f32_32x32x16_bf16 a[112:127], v[104:107], a[208:211], a[112:127]
    s_waitcnt vmcnt(14)
    v_mfma_f32_32x32x16_bf16 a[32:47], v[108:111], a[196:199], a[32:47]
    buffer_load_dwordx4 v[100:103], v35, s[20:23], s38 offen offset:1024 sc1
    v_mfma_f32_32x32x16_bf16 a[48:63], v[108:111], a[212:215], a[48:63]
    s_waitcnt vmcnt(14)
    v_mfma_f32_32x32x16_bf16 a[64:79], v[112:115], a[196:199], a[64:79]
    buffer_load_dwordx4 v[104:107], v35, s[20:23], s36 offen offset:2048 sc1
    v_mfma_f32_32x32x16_bf16 a[80:95], v[112:115], a[212:215], a[80:95]
    s_waitcnt vmcnt(14)
    v_mfma_f32_32x32x16_bf16 a[96:111], v[116:119], a[196:199], a[96:111]
    buffer_load_dwordx4 v[108:111], v35, s[20:23], s37 offen offset:2048 sc1
    v_mfma_f32_32x32x16_bf16 a[112:127], v[116:119], a[212:215], a[112:127]
    s_waitcnt vmcnt(14)
    v_mfma_f32_32x32x16_bf16 a[32:47], v[120:123], a[200:203], a[32:47]
    buffer_load_dwordx4 v[112:115], v35, s[20:23], s38 offen offset:2048 sc1
    v_mfma_f32_32x32x16_bf16 a[48:63], v[120:123], a[216:219], a[48:63]
    s_waitcnt vmcnt(14)
    v_mfma_f32_32x32x16_bf16 a[64:79], v[124:127], a[200:203], a[64:79]
    buffer_load_dwordx4 v[116:119], v35, s[20:23], s36 offen offset:3072 sc1
    v_mfma_f32_32x32x16_bf16 a[80:95], v[124:127], a[216:219], a[80:95]
    s_waitcnt vmcnt(14)
    v_mfma_f32_32x32x16_bf16 a[96:111], v[64:67], a[200:203], a[96:111]
    buffer_load_dwordx4 v[120:123], v35, s[20:23], s37 offen offset:3072 sc1
    v_mfma_f32_32x32x16_bf16 a[112:127], v[64:67], a[216:219], a[112:127]
    s_waitcnt vmcnt(13)
    v_mfma_f32_32x32x16_bf16 a[32:47], v[68:71], a[204:207], a[32:47]
    buffer_load_dwordx4 v[124:127], v35, s[20:23], s38 offen offset:3072 sc1
    v_mfma_f32_32x32x16_bf16 a[48:63], v[68:71], a[220:223], a[48:63]
    s_waitcnt vmcnt(13)
    v_mfma_f32_32x32x16_bf16 a[64:79], v[72:75], a[204:207], a[64:79]
    s_andn2_b32 s68, 983040, s76
    s_cbranch_scc1 Ls_21
Lb_22:
    s_add_u32 s8, s44, 32768
    s_add_u32 s9, s45, 32768
    s_add_u32 s10, s46, 32768
    buffer_load_dwordx4 v[64:67], v35, s[20:23], s8 offen offset:0 sc1
    v_mfma_f32_32x32x16_bf16 a[80:95], v[72:75], a[220:223], a[80:95]
    s_waitcnt vmcnt(13)
    v_mfma_f32_32x32x16_bf16 a[96:111], v[76:79], a[204:207], a[96:111]
    buffer_load_dwordx4 v[68:71], v35, s[20:23], s9 offen offset:0 sc1
    v_mfma_f32_32x32x16_bf16 a[112:127], v[76:79], a[220:223], a[112:127]
    s_waitcnt vmcnt(13)
    v_mfma_f32_32x32x16_bf16 a[32:47], v[80:83], a[224:227], a[32:47]
    buffer_load_dwordx4 v[72:75], v35, s[20:23], s10 offen offset:0 sc1
    v_mfma_f32_32x32x16_bf16 a[48:63], v[80:83], a[0:3], a[48:63]
    s_waitcnt vmcnt(13)
    v_mfma_f32_32x32x16_bf16 a[64:79], v[84:87], a[224:227], a[64:79]
    buffer_load_dwordx4 v[76:79], v35, s[20:23], s8 offen offset:1024 sc1
    v_mfma_f32_32x32x16_bf16 a[80:95], v[84:87], a[0:3], a[80:95]
    s_waitcnt vmcnt(13)
    v_mfma_f32_32x32x16_bf16 a[96:111], v[88:91], a[224:227], a[96:111]
    buffer_load_dwordx4 v[80:83], v35, s[20:23], s9 offen offset:1024 sc1
    v_mfma_f32_32x32x16_bf16 a[112:127], v[88:91], a[0:3], a[112:127]
    s_waitcnt vmcnt(13)
    v_mfma_f32_32x32x16_bf16 a[32:47], v[92:95], a[228:231], a[32:47]
    buffer_load_dwordx4 v[84:87], v35, s[20:23], s10 offen offset:1024 sc1
    v_mfma_f32_32x32x16_bf16 a[48:63], v[92:95], a[4:7], a[48:63]
    s_waitcnt vmcnt(13)
    v_mfma_f32_32x32x16_bf16 a[64:79], v[96:99], a[228:231], a[64:79]
    buffer_load_dwordx4 v[88:91], v35, s[20:23], s8 offen offset:2048 sc1
    v_mfma_f32_32x32x16_bf16 a[80:95], v[96:99], a[4:7], a[80:95]
    v_min_u32 v2, 2, v1
    v_lshlrev_b32 v2, 1, v2
    v_add_u32 v2, s84, v2
    v_max_i32 v2, 0, v2
    v_lshrrev_b32 v2, 3, v2
    v_min_u32 v2, 5, v2
    v_lshlrev_b32 v26, 13, v2
    s_lshl_b32 s64, s39, 7
    s_add_u32 s64, s64, 12713984
    buffer_load_dword v27, v26, s[20:23], s64 offen sc1
    s_waitcnt vmcnt(14)
    v_mfma_f32_32x32x16_bf16 a[96:111], v[100:103], a[228:231], a[96:111]
    buffer_load_dwordx4 v[92:95], v35, s[20:23], s9 offen offset:2048 sc1
    v_mfma_f32_32x32x16_bf16 a[112:127], v[100:103], a[4:7], a[112:127]
    s_waitcnt vmcnt(14)
    v_mfma_f32_32x32x16_bf16 a[32:47], v[104:107], a[232:235], a[32:47]
    buffer_load_dwordx4 v[96:99], v35, s[20:23], s10 offen offset:2048 sc1
    v_mfma_f32_32x32x16_bf16 a[48:63], v[104:107], a[8:11], a[48:63]
    s_waitcnt vmcnt(14)
    v_mfma_f32_32x32x16_bf16 a[64:79], v[108:111], a[232:235], a[64:79]
    buffer_load_dwordx4 v[100:103], v35, s[20:23], s8 offen offset:3072 sc1
    v_mfma_f32_32x32x16_bf16 a[80:95], v[108:111], a[8:11], a[80:95]
    s_waitcnt vmcnt(14)
    v_mfma_f32_32x32x16_bf16 a[96:111], v[112:115], a[232:235], a[96:111]
    buffer_load_dwordx4 v[104:107], v35, s[20:23], s9 offen offset:3072 sc1
    v_mfma_f32_32x32x16_bf16 a[112:127], v[112:115], a[8:11], a[112:127]
    s_waitcnt vmcnt(14)
    v_mfma_f32_32x32x16_bf16 a[32:47], v[116:119], a[236:239], a[32:47]
    buffer_load_dwordx4 v[108:111], v35, s[20:23], s10 offen offset:3072 sc1
    v_mfma_f32_32x32x16_bf16 a[48:63], v[116:119], a[12:15], a[48:63]
    s_waitcnt vmcnt(14)
    v_mfma_f32_32x32x16_bf16 a[64:79], v[120:123], a[236:239], a[64:79]
    s_andn2_b32 s68, 15728640, s76
    s_cbranch_scc1 Ls_23
Lb_24:
    s_add_u32 s36, s44, 40960
    s_add_u32 s37, s45, 40960
    s_add_u32 s38, s46, 40960
    buffer_load_dwordx4 v[112:115], v35, s[20:23], s36 offen offset:0 sc1
    v_mfma_f32_32x32x16_bf16 a[80:95], v[120:123], a[12:15], a[80:95]
    ds_read_b128 v[140:143], v20 offset:16384
    s_waitcnt vmcnt(14)
    v_mfma_f32_32x32x16_bf16 a[96:111], v[124:127], a[236:239], a[96:111]
    buffer_load_dwordx4 v[116:119], v35, s[20:23], s37 offen offset:0 sc1
    v_mfma_f32_32x32x16_bf16 a[112:127], v[124:127], a[12:15], a[112:127]
    s_waitcnt vmcnt(14) lgkmcnt(0)
    v_mfma_f32_32x32x16_bf16 a[32:47], v[64:67], a[16:19], a[32:47]
    buffer_load_dwordx4 v[120:123], v35, s[20:23], s38 offen offset:0 sc1
    v_mfma_f32_32x32x16_bf16 a[48:63], v[64:67], v[140:143], a[48:63]
    s_waitcnt vmcnt(14)
    v_mfma_f32_32x32x16_bf16 a[64:79], v[68:71], a[16:19], a[64:79]
    buffer_load_dwordx4 v[124:127], v35, s[20:23], s36 offen offset:1024 sc1
    ds_read_b128 v[148:151], v21 offset:16384
    v_mfma_f32_32x32x16_bf16 a[80:95], v[68:71], v[140:143], a[80:95]
    s_waitcnt vmcnt(14)
    v_mfma_f32_32x32x16_bf16 a[96:111], v[72:75], a[16:19], a[96:111]
    ds_read_b128 a[192:195], v20 offset:24576
    buffer_load_dwordx4 v[64:67], v35, s[20:23], s37 offen offset:1024 sc1
    v_mfma_f32_32x32x16_bf16 a[112:127], v[72:75], v[140:143], a[112:127]
    s_barrier
    s_waitcnt vmcnt(14) lgkmcnt(1)
    v_mfma_f32_32x32x16_bf16 a[32:47], v[76:79], a[20:23], a[32:47]
    ds_read_b128 a[196:199], v21 offset:24576
    buffer_load_dwordx4 v[68:71], v35, s[20:23], s38 offen offset:1024 sc1
    v_mfma_f32_32x32x16_bf16 a[48:63], v[76:79], v[148:151], a[48:63]
    s_waitcnt vmcnt(14)
    v_mfma_f32_32x32x16_bf16 a[64:79], v[80:83], a[20:23], a[64:79]
    buffer_load_dwordx4 v[72:75], v35, s[20:23], s36 offen offset:2048 sc1
    ds_read_b128 v[132:135], v22 offset:16384
    v_mfma_f32_32x32x16_bf16 a[80:95], v[80:83], v[148:151], a[80:95]
    ds_read_b128 a[200:203], v22 offset:24576
    s_waitcnt vmcnt(14)
    v_mfma_f32_32x32x16_bf16 a[96:111], v[84:87], a[20:23], a[96:111]
    ds_read_b128 a[204:207], v23 offset:24576
    buffer_load_dwordx4 v[76:79], v35, s[20:23], s37 offen offset:2048 sc1
    v_mfma_f32_32x32x16_bf16 a[112:127], v[84:87], v[148:151], a[112:127]
    s_waitcnt vmcnt(14) lgkmcnt(2)
    v_mfma_f32_32x32x16_bf16 a[32:47], v[88:91], a[24:27], a[32:47]
    ds_read_b128 a[208:211], v20 offset:28672
    buffer_load_dwordx4 v[80:83], v35, s[20:23], s38 offen offset:2048 sc1
    v_mfma_f32_32x32x16_bf16 a[48:63], v[88:91], v[132:135], a[48:63]
    s_waitcnt vmcnt(13)
    v_mfma_f32_32x32x16_bf16 a[64:79], v[92:95], a[24:27], a[64:79]
    buffer_load_dwordx4 v[84:87], v35, s[20:23], s36 offen offset:3072 sc1
    ds_read_b128 v[140:143], v23 offset:16384
    v_mfma_f32_32x32x16_bf16 a[80:95], v[92:95], v[132:135], a[80:95]
    ds_read_b128 a[212:215], v21 offset:28672
    s_waitcnt vmcnt(13)
    v_mfma_f32_32x32x16_bf16 a[96:111], v[96:99], a[24:27], a[96:111]
    ds_read_b128 a[216:219], v22 offset:28672
    buffer_load_dwordx4 v[88:91], v35, s[20:23], s37 offen offset:3072 sc1
    v_mfma_f32_32x32x16_bf16 a[112:127], v[96:99], v[132:135], a[112:127]
    s_waitcnt vmcnt(13) lgkmcnt(2)
    v_mfma_f32_32x32x16_bf16 a[32:47], v[100:103], a[28:31], a[32:47]
    ds_read_b128 a[220:223], v23 offset:28672
    buffer_load_dwordx4 v[92:95], v35, s[20:23], s38 offen offset:3072 sc1
    v_mfma_f32_32x32x16_bf16 a[48:63], v[100:103], v[140:143], a[48:63]
    s_waitcnt vmcnt(13)
    v_mfma_f32_32x32x16_bf16 a[64:79], v[104:107], a[28:31], a[64:79]
    ds_read_b128 v[144:147], v20 offset:20480
    s_andn2_b32 s68, 251658240, s76
    s_cbranch_scc1 Ls_25
Lb_26:
    s_add_u32 s8, s44, 49152
    s_add_u32 s9, s45, 49152
    s_add_u32 s10, s46, 49152
    buffer_load_dwordx4 v[96:99], v35, s[20:23], s8 offen offset:0 sc1
    v_mfma_f32_32x32x16_bf16 a[80:95], v[104:107], v[140:143], a[80:95]
    ds_read_b128 v[148:151], v20 offset:8192
    ds_read_b128 a[224:227], v20 offset:0
    s_waitcnt vmcnt(13)
    v_mfma_f32_32x32x16_bf16 a[96:111], v[108:111], a[28:31], a[96:111]
    ds_read_b128 a[228:231], v21 offset:0
    buffer_load_dwordx4 v[100:103], v35, s[20:23], s8 offen offset:1024 sc1
    v_mfma_f32_32x32x16_bf16 a[112:127], v[108:111], v[140:143], a[112:127]
    s_waitcnt vmcnt(13) lgkmcnt(2)
    v_mfma_f32_32x32x16_bf16 a[32:47], v[112:115], v[144:147], a[32:47]
    ds_read_b128 a[232:235], v22 offset:0
    buffer_load_dwordx4 v[104:107], v35, s[20:23], s8 offen offset:2048 sc1
    v_mfma_f32_32x32x16_bf16 a[48:63], v[112:115], v[148:151], a[48:63]
    s_waitcnt vmcnt(13)
    v_mfma_f32_32x32x16_bf16 a[64:79], v[116:119], v[144:147], a[64:79]
    ds_read_b128 v[128:131], v21 offset:20480
    buffer_load_dwordx4 v[108:111], v35, s[20:23], s8 offen offset:3072 sc1
    v_mfma_f32_32x32x16_bf16 a[80:95], v[116:119], v[148:151], a[80:95]
    ds_read_b128 v[132:135], v21 offset:8192
    ds_read_b128 a[236:239], v23 offset:0
    s_waitcnt vmcnt(13)
    v_mfma_f32_32x32x16_bf16 a[96:111], v[120:123], v[144:147], a[96:111]
    ds_read_b128 a[0:3], v20 offset:4096
    s_andn2_b32 s68, 4026531840, s76
    s_cbranch_scc1 Ls_27
Lb_28:
    s_add_u32 s36, s44, 57344
    s_add_u32 s37, s45, 57344
    s_add_u32 s38, s46, 57344
    buffer_load_dwordx4 v[112:115], v35, s[20:23], s36 offen offset:0 sc1
    v_mfma_f32_32x32x16_bf16 a[112:127], v[120:123], v[148:151], a[112:127]
    s_waitcnt vmcnt(13) lgkmcnt(2)
    v_mfma_f32_32x32x16_bf16 a[32:47], v[124:127], v[128:131], a[32:47]
    ds_read_b128 a[4:7], v21 offset:4096
    buffer_load_dwordx4 v[116:119], v35, s[20:23], s36 offen offset:1024 sc1
    v_mfma_f32_32x32x16_bf16 a[48:63], v[124:127], v[132:135], a[48:63]
    s_waitcnt vmcnt(13)
    v_mfma_f32_32x32x16_bf16 a[64:79], v[64:67], v[128:131], a[64:79]
    ds_read_b128 v[136:139], v22 offset:20480
    buffer_load_dwordx4 v[120:123], v35, s[20:23], s36 offen offset:2048 sc1
    v_mfma_f32_32x32x16_bf16 a[80:95], v[64:67], v[132:135], a[80:95]
    ds_read_b128 v[140:143], v22 offset:8192
    ds_read_b128 a[8:11], v22 offset:4096
    s_waitcnt vmcnt(13)
    v_mfma_f32_32x32x16_bf16 a[96:111], v[68:71], v[128:131], a[96:111]
    ds_read_b128 a[12:15], v23 offset:4096
    buffer_load_dwordx4 v[124:127], v35, s[20:23], s36 offen offset:3072 sc1
    v_mfma_f32_32x32x16_bf16 a[112:127], v[68:71], v[132:135], a[112:127]
    s_waitcnt vmcnt(13) lgkmcnt(2)
    v_mfma_f32_32x32x16_bf16 a[32:47], v[72:75], v[136:139], a[32:47]
    buffer_load_dwordx4 v[64:67], v35, s[20:23], s9 offen offset:0 sc1
    v_mfma_f32_32x32x16_bf16 a[48:63], v[72:75], v[140:143], a[48:63]
    s_waitcnt vmcnt(13)
    v_mfma_f32_32x32x16_bf16 a[64:79], v[76:79], v[136:139], a[64:79]
    ds_read_b128 v[144:147], v23 offset:20480
    buffer_load_dwordx4 v[68:71], v35, s[20:23], s9 offen offset:1024 sc1
    v_mfma_f32_32x32x16_bf16 a[80:95], v[76:79], v[140:143], a[80:95]
    ds_read_b128 v[148:151], v23 offset:8192
    s_waitcnt vmcnt(13)
    v_mfma_f32_32x32x16_bf16 a[96:111], v[80:83], v[136:139], a[96:111]
    buffer_load_dwordx4 v[72:75], v35, s[20:23], s9 offen offset:2048 sc1
    v_mfma_f32_32x32x16_bf16 a[112:127], v[80:83], v[140:143], a[112:127]
    s_waitcnt vmcnt(13) lgkmcnt(0)
    v_mfma_f32_32x32x16_bf16 a[32:47], v[84:87], v[144:147], a[32:47]
    buffer_load_dwordx4 v[76:79], v35, s[20:23], s9 offen offset:3072 sc1
    v_mfma_f32_32x32x16_bf16 a[48:63], v[84:87], v[148:151], a[48:63]
    s_waitcnt vmcnt(13)
    v_mfma_f32_32x32x16_bf16 a[64:79], v[88:91], v[144:147], a[64:79]
    buffer_load_dwordx4 v[80:83], v35, s[20:23], s37 offen offset:0 sc1
    v_mfma_f32_32x32x16_bf16 a[80:95], v[88:91], v[148:151], a[80:95]
    v_cmp_ne_u32 vcc, s53, v27
    s_nop 1
    s_and_b32 s68, vcc_lo, 7
    s_cbranch_scc1 Ls_29
Lb_30:
    s_mul_i32 s71, s39, 44
    s_add_u32 s71, s71, s84
    s_lshl_b32 s58, s71, 10
    s_add_u32 s71, s58, 4194304
    buffer_load_dwordx4 v[44:47], v0, s[20:23], s71 offen sc1
    s_waitcnt vmcnt(14)
    v_mfma_f32_32x32x16_bf16 a[96:111], v[92:95], v[144:147], a[96:111]
    buffer_load_dwordx4 v[84:87], v35, s[20:23], s37 offen offset:1024 sc1
    v_mfma_f32_32x32x16_bf16 a[112:127], v[92:95], v[148:151], a[112:127]
    s_waitcnt vmcnt(14)
    v_mfma_f32_32x32x16_bf16 a[32:47], v[96:99], a[192:195], a[32:47]
    buffer_load_dwordx4 v[88:91], v35, s[20:23], s37 offen offset:2048 sc1
    v_mfma_f32_32x32x16_bf16 a[48:63], v[96:99], a[208:211], a[48:63]
    s_add_u32 s71, s58, 4196352
    buffer_load_dwordx4 v[48:51], v0, s[20:23], s71 offen sc1
    s_waitcnt vmcnt(15)
    v_mfma_f32_32x32x16_bf16 a[32:47], v[100:103], a[196:199], a[32:47]
    buffer_load_dwordx4 v[92:95], v35, s[20:23], s37 offen offset:3072 sc1
    v_mfma_f32_32x32x16_bf16 a[48:63], v[100:103], a[212:215], a[48:63]
    s_waitcnt vmcnt(15)
    v_mfma_f32_32x32x16_bf16 a[32:47], v[104:107], a[200:203], a[32:47]
    buffer_load_dwordx4 v[96:99], v35, s[20:23], s10 offen offset:0 sc1
    v_mfma_f32_32x32x16_bf16 a[48:63], v[104:107], a[216:219], a[48:63]
    s_add_u32 s71, s58, 4198400
    buffer_load_dwordx4 v[52:55], v0, s[20:23], s71 offen sc1
    s_waitcnt vmcnt(16)
    v_mfma_f32_32x32x16_bf16 a[32:47], v[108:111], a[204:207], a[32:47]
    buffer_load_dwordx4 v[100:103], v35, s[20:23], s10 offen offset:1024 sc1
    v_mfma_f32_32x32x16_bf16 a[48:63], v[108:111], a[220:223], a[48:63]
    s_waitcnt vmcnt(16)
    v_mfma_f32_32x32x16_bf16 a[32:47], v[112:115], a[224:227], a[32:47]
    buffer_load_dwordx4 v[104:107], v35, s[20:23], s10 offen offset:2048 sc1
    v_mfma_f32_32x32x16_bf16 a[48:63], v[112:115], a[0:3], a[48:63]
    s_waitcnt vmcnt(16)
    v_mfma_f32_32x32x16_bf16 a[32:47], v[116:119], a[228:231], a[32:47]
    buffer_load_dwordx4 v[108:111], v35, s[20:23], s10 offen offset:3072 sc1
    v_mfma_f32_32x32x16_bf16 a[48:63], v[116:119], a[4:7], a[48:63]
    s_waitcnt vmcnt(16)
    v_mfma_f32_32x32x16_bf16 a[32:47], v[120:123], a[232:235], a[32:47]
    buffer_load_dwordx4 v[112:115], v35, s[20:23], s38 offen offset:0 sc1
    v_mfma_f32_32x32x16_bf16 a[48:63], v[120:123], a[8:11], a[48:63]
    s_waitcnt vmcnt(16)
    v_mfma_f32_32x32x16_bf16 a[32:47], v[124:127], a[236:239], a[32:47]
    buffer_load_dwordx4 v[116:119], v35, s[20:23], s38 offen offset:1024 sc1
    v_mfma_f32_32x32x16_bf16 a[48:63], v[124:127], a[12:15], a[48:63]
    s_waitcnt vmcnt(16)
    v_mfma_f32_32x32x16_bf16 a[64:79], v[64:67], a[192:195], a[64:79]
    buffer_load_dwordx4 v[120:123], v35, s[20:23], s38 offen offset:2048 sc1
    v_mfma_f32_32x32x16_bf16 a[80:95], v[64:67], a[208:211], a[80:95]
    s_waitcnt vmcnt(16)
    v_mfma_f32_32x32x16_bf16 a[64:79], v[68:71], a[196:199], a[64:79]
    buffer_load_dwordx4 v[124:127], v35, s[20:23], s38 offen offset:3072 sc1
    v_mfma_f32_32x32x16_bf16 a[80:95], v[68:71], a[212:215], a[80:95]
    s_waitcnt vmcnt(16)
    v_mfma_f32_32x32x16_bf16 a[64:79], v[72:75], a[200:203], a[64:79]
    ds_write_b128 v6, a[40:43] offset:14336
    s_add_u32 m0, s79, 131072
    v_mfma_f32_32x32x16_bf16 a[80:95], v[72:75], a[216:219], a[80:95]
    s_add_u32 s74, s4, 262144
    buffer_load_dwordx4 v16, s[32:35], s74 offen offset:0 lds
    s_waitcnt vmcnt(16)
    v_mfma_f32_32x32x16_bf16 a[64:79], v[76:79], a[204:207], a[64:79]
    ds_write_b128 v6, a[44:47] offset:15360
    v_mfma_f32_32x32x16_bf16 a[80:95], v[76:79], a[220:223], a[80:95]
    buffer_load_dwordx4 v17, s[32:35], s74 offen offset:1024 lds
    s_waitcnt vmcnt(16)
    v_mfma_f32_32x32x16_bf16 a[64:79], v[80:83], a[224:227], a[64:79]
    ds_write_b128 v6, a[48:51] offset:12288
    s_waitcnt vmcnt(9)
    v_mfma_f32_32x32x16_bf16 a[80:95], v[80:83], a[0:3], a[80:95]
    v_accvgpr_read_b32 v176, a32
    v_accvgpr_read_b32 v177, a33
    v_accvgpr_read_b32 v178, a34
    v_accvgpr_read_b32 v179, a35
    v_accvgpr_read_b32 v180, a36
    v_accvgpr_read_b32 v181, a37
    v_mfma_f32_32x32x16_bf16 a[64:79], v[84:87], a[228:231], a[64:79]
    ds_write_b128 v6, a[52:55] offset:13312
    v_accvgpr_read_b32 v182, a38
    v_accvgpr_read_b32 v183, a39
    v_mfma_f32_32x32x16_bf16 a[80:95], v[84:87], a[4:7], a[80:95]
    buffer_load_dwordx4 v18, s[32:35], s74 offen offset:2048 lds
    v_lshlrev_b32 v208, 16, v44
    v_and_b32 v209, 0xffff0000, v44
    v_mfma_f32_32x32x16_bf16 a[64:79], v[88:91], a[232:235], a[64:79]
    ds_write_b128 v6, a[56:59] offset:16384
    v_lshlrev_b32 v210, 16, v45
    v_and_b32 v211, 0xffff0000, v45
    v_mfma_f32_32x32x16_bf16 a[80:95], v[88:91], a[8:11], a[80:95]
    v_lshlrev_b32 v212, 16, v46
    v_and_b32 v213, 0xffff0000, v46
    v_lshlrev_b32 v214, 16, v47
    v_and_b32 v215, 0xffff0000, v47
    v_add_f32 v176, v176, v32
    v_add_f32 v177, v177, v32
    v_mfma_f32_32x32x16_bf16 a[64:79], v[92:95], a[236:239], a[64:79]
    ds_write_b128 v6, a[60:63] offset:17408
    v_add_f32 v178, v178, v32
    v_add_f32 v179, v179, v32
    v_add_f32 v180, v180, v32
    v_mfma_f32_32x32x16_bf16 a[80:95], v[92:95], a[12:15], a[80:95]
    buffer_load_dwordx4 v19, s[32:35], s74 offen offset:3072 lds
    v_add_f32 v181, v181, v32
    v_add_f32 v182, v182, v32
    v_add_f32 v183, v183, v32
    s_add_u32 s71, s84, 0
    s_add_u32 s70, s58, 7340032
    s_cmp_le_u32 s71, 42
    s_cselect_b32 s70, s70, 1073741824
    v_mfma_f32_32x32x16_bf16 a[96:111], v[96:99], a[192:195], a[96:111]
    s_waitcnt lgkmcnt(0)
    s_barrier
    ds_read_b128 v[184:187], v7 offset:12288
    ds_read_b128 v[188:191], v7 offset:13312
    ds_read_b128 v[192:195], v8 offset:14336
    ds_read_b128 v[196:199], v8 offset:15360
    v_mfma_f32_32x32x16_bf16 a[112:127], v[96:99], a[208:211], a[112:127]
    ds_read_b128 v[200:203], v9 offset:16384
    ds_read_b128 v[204:207], v9 offset:17408
    s_waitcnt vmcnt(10)
    v_mfma_f32_32x32x16_bf16 a[96:111], v[100:103], a[196:199], a[96:111]
    ds_write_b128 v6, a[72:75] offset:20480
    v_mfma_f32_32x32x16_bf16 a[112:127], v[100:103], a[212:215], a[112:127]
    s_waitcnt vmcnt(9)
    v_mfma_f32_32x32x16_bf16 a[96:111], v[104:107], a[200:203], a[96:111]
    ds_write_b128 v6, a[76:79] offset:21504
    v_mfma_f32_32x32x16_bf16 a[112:127], v[104:107], a[216:219], a[112:127]
    s_waitcnt vmcnt(8)
    v_mfma_f32_32x32x16_bf16 a[96:111], v[108:111], a[204:207], a[96:111]
    s_waitcnt lgkmcnt(2)
    v_add_f32 v176, v176, v184
    v_add_f32 v177, v177, v185
    v_add_f32 v178, v178, v186
    v_add_f32 v179, v179, v187
    v_mfma_f32_32x32x16_bf16 a[112:127], v[108:111], a[220:223], a[112:127]
    v_add_f32 v180, v180, v188
    ds_write_b128 v6, a[80:83] offset:18432
    v_add_f32 v181, v181, v189
    s_waitcnt vmcnt(7)
    v_mfma_f32_32x32x16_bf16 a[96:111], v[112:115], a[224:227], a[96:111]
    v_add_f32 v182, v182, v190
    v_add_f32 v183, v183, v191
    v_add_f32 v176, v176, v192
    v_add_f32 v177, v177, v193
    v_add_f32 v178, v178, v194
    v_mfma_f32_32x32x16_bf16 a[112:127], v[112:115], a[0:3], a[112:127]
    v_add_f32 v179, v179, v195
    v_add_f32 v180, v180, v196
    v_add_f32 v181, v181, v197
    s_waitcnt vmcnt(6)
    v_mfma_f32_32x32x16_bf16 a[96:111], v[116:119], a[228:231], a[96:111]
    ds_write_b128 v6, a[84:87] offset:19456
    v_add_f32 v182, v182, v198
    v_mfma_f32_32x32x16_bf16 a[112:127], v[116:119], a[4:7], a[112:127]
    v_add_f32 v183, v183, v199
    v_add_f32 v176, v176, v200
    v_add_f32 v177, v177, v201
    v_add_f32 v178, v178, v202
    v_add_f32 v179, v179, v203
    v_add_f32 v180, v180, v204
    s_waitcnt vmcnt(5)
    v_mfma_f32_32x32x16_bf16 a[96:111], v[120:123], a[232:235], a[96:111]
    v_add_f32 v181, v181, v205
    v_add_f32 v182, v182, v206
    v_mfma_f32_32x32x16_bf16 a[112:127], v[120:123], a[8:11], a[112:127]
    ds_write_b128 v6, a[88:91] offset:22528
    v_add_f32 v183, v183, v207
    v_mul_f32 v176, v176, v208
    s_waitcnt vmcnt(4)
    v_mfma_f32_32x32x16_bf16 a[96:111], v[124:127], a[236:239], a[96:111]
    v_mul_f32 v177, v177, v209
    v_mul_f32 v178, v178, v210
    v_mul_f32 v179, v179, v211
    v_mul_f32 v180, v180, v212
    v_mul_f32 v181, v181, v213
    v_mfma_f32_32x32x16_bf16 a[112:127], v[124:127], a[12:15], a[112:127]
    v_mul_f32 v182, v182, v214
    v_mul_f32 v183, v183, v215
    ds_write_b128 v6, a[92:95] offset:23552
    v_cvt_pk_bf16_f32 v208, v176, v177
    v_cvt_pk_bf16_f32 v209, v178, v179
    v_cvt_pk_bf16_f32 v210, v180, v181
    v_cvt_pk_bf16_f32 v211, v182, v183
    buffer_store_dwordx4 v[208:211], v0, s[20:23], s70 offen sc1
    s_branch LJ_10
LY_9:
    s_nop 3
    s_lshl_b32 s83, s50, 6
    s_add_u32 s83, s83, s63
    s_lshl_b32 s83, s83, 7
    s_add_u32 s83, s83, 12713984
    s_nop 5
    v_pk_mul_f32 v[160:161], v[128:129], v[128:129]
    v_pk_mul_f32 v[162:163], v[130:131], v[130:131]
    v_pk_mul_f32 v[164:165], v[132:133], v[132:133]
    v_pk_mul_f32 v[166:167], v[134:135], v[134:135]
    v_pk_fma_f32 v[160:161], v[160:161], v[46:47], v[44:45] op_sel_hi:[1,0,0]
    v_pk_fma_f32 v[162:163], v[162:163], v[46:47], v[44:45] op_sel_hi:[1,0,0]
    v_pk_fma_f32 v[164:165], v[164:165], v[46:47], v[44:45] op_sel_hi:[1,0,0]
    v_pk_fma_f32 v[166:167], v[166:167], v[46:47], v[44:45] op_sel_hi:[1,0,0]
    v_pk_mul_f32 v[160:161], v[160:161], v[128:129]
    v_pk_mul_f32 v[162:163], v[162:163], v[130:131]
    v_pk_mul_f32 v[164:165], v[164:165], v[132:133]
    v_pk_mul_f32 v[166:167], v[166:167], v[134:135]
    v_exp_f32 v160, v160
    v_exp_f32 v161, v161
    ds_read_b128 a[0:3], v20 offset:0
    ds_read_b128 a[4:7], v21 offset:0
    ds_read_b128 a[8:11], v22 offset:0
    ds_read_b128 a[12:15], v23 offset:0
    ds_read_b128 a[16:19], v20 offset:4096
    ds_read_b128 a[20:23], v21 offset:4096
    ds_read_b128 a[24:27], v22 offset:4096
    ds_read_b128 a[28:31], v23 offset:4096
    s_waitcnt vmcnt(6)
    v_cmp_eq_u32 vcc, s53, v59
    s_nop 1
    s_mov_b32 s76, vcc_lo
    s_andn2_b32 s68, 15, s76
    s_cbranch_scc1 Ls_31
Lb_32:
    s_add_u32 s8, s44, 0
    s_add_u32 s9, s45, 0
    s_add_u32 s10, s46, 0
    buffer_load_dwordx4 v[64:67], v35, s[20:23], s8 offen offset:0 sc1
    v_exp_f32 v162, v162
    v_exp_f32 v163, v163
    v_exp_f32 v164, v164
    v_exp_f32 v165, v165
    v_exp_f32 v166, v166
    v_exp_f32 v167, v167
    v_pk_fma_f32 v[160:161], v[160:161], v[48:49], v[48:49] op_sel_hi:[1,0,0]
    v_pk_fma_f32 v[162:163], v[162:163], v[48:49], v[48:49] op_sel_hi:[1,0,0]
    v_pk_fma_f32 v[164:165], v[164:165], v[48:49], v[48:49] op_sel_hi:[1,0,0]
    v_pk_fma_f32 v[166:167], v[166:167], v[48:49], v[48:49] op_sel_hi:[1,0,0]
    buffer_load_dwordx4 v[68:71], v35, s[20:23], s9 offen offset:0 sc1
    v_rcp_f32 v160, v160
    v_rcp_f32 v161, v161
    v_rcp_f32 v162, v162
    v_rcp_f32 v163, v163
    v_rcp_f32 v164, v164
    v_rcp_f32 v165, v165
    v_rcp_f32 v166, v166
    v_rcp_f32 v167, v167
    buffer_load_dwordx4 v[72:75], v35, s[20:23], s10 offen offset:0 sc1
    v_pk_mul_f32 v[128:129], v[160:161], v[128:129]
    v_pk_mul_f32 v[130:131], v[162:163], v[130:131]
    v_pk_mul_f32 v[132:133], v[164:165], v[132:133]
    v_pk_mul_f32 v[134:135], v[166:167], v[134:135]
    v_pk_mul_f32 v[160:161], v[136:137], v[136:137]
    v_pk_mul_f32 v[162:163], v[138:139], v[138:139]
    v_pk_mul_f32 v[164:165], v[140:141], v[140:141]
    v_pk_mul_f32 v[166:167], v[142:143], v[142:143]
    v_pk_fma_f32 v[160:161], v[160:161], v[46:47], v[44:45] op_sel_hi:[1,0,0]
    v_pk_fma_f32 v[162:163], v[162:163], v[46:47], v[44:45] op_sel_hi:[1,0,0]
    v_pk_fma_f32 v[164:165], v[164:165], v[46:47], v[44:45] op_sel_hi:[1,0,0]
    v_pk_fma_f32 v[166:167], v[166:167], v[46:47], v[44:45] op_sel_hi:[1,0,0]
    v_pk_mul_f32 v[160:161], v[160:161], v[136:137]
    v_pk_mul_f32 v[162:163], v[162:163], v[138:139]
    v_pk_mul_f32 v[164:165], v[164:165], v[140:141]
    v_pk_mul_f32 v[166:167], v[166:167], v[142:143]
    buffer_load_dwordx4 v[76:79], v35, s[20:23], s8 offen offset:1024 sc1
    v_exp_f32 v160, v160
    v_exp_f32 v161, v161
    v_exp_f32 v162, v162
    v_exp_f32 v163, v163
    v_exp_f32 v164, v164
    v_exp_f32 v165, v165
    v_exp_f32 v166, v166
    v_exp_f32 v167, v167
    buffer_load_dwordx4 v[80:83], v35, s[20:23], s9 offen offset:1024 sc1
    v_pk_fma_f32 v[160:161], v[160:161], v[48:49], v[48:49] op_sel_hi:[1,0,0]
    v_pk_fma_f32 v[162:163], v[162:163], v[48:49], v[48:49] op_sel_hi:[1,0,0]
    v_pk_fma_f32 v[164:165], v[164:165], v[48:49], v[48:49] op_sel_hi:[1,0,0]
    v_pk_fma_f32 v[166:167], v[166:167], v[48:49], v[48:49] op_sel_hi:[1,0,0]
    v_rcp_f32 v160, v160
    v_rcp_f32 v161, v161
    v_rcp_f32 v162, v162
    v_rcp_f32 v163, v163
    v_rcp_f32 v164, v164
    v_rcp_f32 v165, v165
    buffer_load_dwordx4 v[84:87], v35, s[20:23], s10 offen offset:1024 sc1
    v_rcp_f32 v166, v166
    v_rcp_f32 v167, v167
    v_pk_mul_f32 v[136:137], v[160:161], v[136:137]
    v_pk_mul_f32 v[138:139], v[162:163], v[138:139]
    v_pk_mul_f32 v[140:141], v[164:165], v[140:141]
    v_pk_mul_f32 v[142:143], v[166:167], v[142:143]
    v_pk_mul_f32 v[160:161], v[144:145], v[144:145]
    v_pk_mul_f32 v[162:163], v[146:147], v[146:147]
    v_pk_mul_f32 v[164:165], v[148:149], v[148:149]
    v_pk_mul_f32 v[166:167], v[150:151], v[150:151]
    v_pk_fma_f32 v[160:161], v[160:161], v[46:47], v[44:45] op_sel_hi:[1,0,0]
    v_pk_fma_f32 v[162:163], v[162:163], v[46:47], v[44:45] op_sel_hi:[1,0,0]
    v_pk_fma_f32 v[164:165], v[164:165], v[46:47], v[44:45] op_sel_hi:[1,0,0]
    v_pk_fma_f32 v[166:167], v[166:167], v[46:47], v[44:45] op_sel_hi:[1,0,0]
    buffer_load_dwordx4 v[88:91], v35, s[20:23], s8 offen offset:2048 sc1
    v_pk_mul_f32 v[160:161], v[160:161], v[144:145]
    v_pk_mul_f32 v[162:163], v[162:163], v[146:147]
    v_pk_mul_f32 v[164:165], v[164:165], v[148:149]
    v_pk_mul_f32 v[166:167], v[166:167], v[150:151]
    v_exp_f32 v160, v160
    v_exp_f32 v161, v161
    v_exp_f32 v162, v162
    v_exp_f32 v163, v163
    v_exp_f32 v164, v164
    v_exp_f32 v165, v165
    buffer_load_dwordx4 v[92:95], v35, s[20:23], s9 offen offset:2048 sc1
    v_exp_f32 v166, v166
    v_exp_f32 v167, v167
    v_pk_fma_f32 v[160:161], v[160:161], v[48:49], v[48:49] op_sel_hi:[1,0,0]
    v_pk_fma_f32 v[162:163], v[162:163], v[48:49], v[48:49] op_sel_hi:[1,0,0]
    v_pk_fma_f32 v[164:165], v[164:165], v[48:49], v[48:49] op_sel_hi:[1,0,0]
    v_pk_fma_f32 v[166:167], v[166:167], v[48:49], v[48:49] op_sel_hi:[1,0,0]
    v_rcp_f32 v160, v160
    v_rcp_f32 v161, v161
    v_rcp_f32 v162, v162
    v_rcp_f32 v163, v163
    buffer_load_dwordx4 v[96:99], v35, s[20:23], s10 offen offset:2048 sc1
    v_rcp_f32 v164, v164
    v_rcp_f32 v165, v165
    v_rcp_f32 v166, v166
    v_rcp_f32 v167, v167
    v_pk_mul_f32 v[144:145], v[160:161], v[144:145]
    v_pk_mul_f32 v[146:147], v[162:163], v[146:147]
    v_pk_mul_f32 v[148:149], v[164:165], v[148:149]
    v_pk_mul_f32 v[150:151], v[166:167], v[150:151]
    v_pk_mul_f32 v[160:161], v[152:153], v[152:153]
    v_pk_mul_f32 v[162:163], v[154:155], v[154:155]
    v_pk_mul_f32 v[164:165], v[156:157], v[156:157]
    v_pk_mul_f32 v[166:167], v[158:159], v[158:159]
    buffer_load_dwordx4 v[100:103], v35, s[20:23], s8 offen offset:3072 sc1
    v_pk_fma_f32 v[160:161], v[160:161], v[46:47], v[44:45] op_sel_hi:[1,0,0]
    v_pk_fma_f32 v[162:163], v[162:163], v[46:47], v[44:45] op_sel_hi:[1,0,0]
    v_pk_fma_f32 v[164:165], v[164:165], v[46:47], v[44:45] op_sel_hi:[1,0,0]
    v_pk_fma_f32 v[166:167], v[166:167], v[46:47], v[44:45] op_sel_hi:[1,0,0]
    v_pk_mul_f32 v[160:161], v[160:161], v[152:153]
    v_pk_mul_f32 v[162:163], v[162:163], v[154:155]
    v_pk_mul_f32 v[164:165], v[164:165], v[156:157]
    v_pk_mul_f32 v[166:167], v[166:167], v[158:159]
    v_exp_f32 v160, v160
    v_exp_f32 v161, v161
    v_exp_f32 v162, v162
    v_exp_f32 v163, v163
    buffer_load_dwordx4 v[104:107], v35, s[20:23], s9 offen offset:3072 sc1
    v_exp_f32 v164, v164
    v_exp_f32 v165, v165
    v_exp_f32 v166, v166
    v_exp_f32 v167, v167
    v_pk_fma_f32 v[160:161], v[160:161], v[48:49], v[48:49] op_sel_hi:[1,0,0]
    v_pk_fma_f32 v[162:163], v[162:163], v[48:49], v[48:49] op_sel_hi:[1,0,0]
    v_pk_fma_f32 v[164:165], v[164:165], v[48:49], v[48:49] op_sel_hi:[1,0,0]
    v_pk_fma_f32 v[166:167], v[166:167], v[48:49], v[48:49] op_sel_hi:[1,0,0]
    v_rcp_f32 v160, v160
    v_rcp_f32 v161, v161
    buffer_load_dwordx4 v[108:111], v35, s[20:23], s10 offen offset:3072 sc1
    v_rcp_f32 v162, v162
    v_rcp_f32 v163, v163
    v_rcp_f32 v164, v164
    v_rcp_f32 v165, v165
    v_rcp_f32 v166, v166
    v_rcp_f32 v167, v167
    v_pk_mul_f32 v[152:153], v[160:161], v[152:153]
    v_pk_mul_f32 v[154:155], v[162:163], v[154:155]
    v_pk_mul_f32 v[156:157], v[164:165], v[156:157]
    v_pk_mul_f32 v[158:159], v[166:167], v[158:159]
    s_andn2_b32 s68, 240, s76
    s_cbranch_scc1 Ls_33
Lb_34:
    s_add_u32 s36, s44, 8192
    s_add_u32 s37, s45, 8192
    s_add_u32 s38, s46, 8192
    buffer_load_dwordx4 v[112:115], v35, s[20:23], s36 offen offset:0 sc1
    buffer_load_dwordx4 v[116:119], v35, s[20:23], s37 offen offset:0 sc1
    s_waitcnt lgkmcnt(4)
    s_add_u32 m0, s54, 0
    s_add_u32 s74, s81, 1792
    buffer_load_dwordx4 v16, s[16:19], s74 offen offset:0 lds
    buffer_load_dwordx4 v17, s[16:19], s74 offen offset:1024 lds
    buffer_load_dwordx4 v18, s[16:19], s74 offen offset:2048 lds
    buffer_load_dwordx4 v19, s[16:19], s74 offen offset:3072 lds
    s_waitcnt lgkmcnt(0)
    s_add_u32 m0, s54, 4096
    s_add_u32 s75, s85, 1792
    buffer_load_dwordx4 v16, s[16:19], s75 offen offset:0 lds
    buffer_load_dwordx4 v17, s[16:19], s75 offen offset:1024 lds
    buffer_load_dwordx4 v18, s[16:19], s75 offen offset:2048 lds
    buffer_load_dwordx4 v19, s[16:19], s75 offen offset:3072 lds
    v_cvt_pk_bf16_f32 v176, v128, v129
    v_cvt_pk_bf16_f32 v177, v130, v131
    v_cvt_pk_bf16_f32 v178, v132, v133
    v_cvt_pk_bf16_f32 v179, v134, v135
    v_cvt_pk_bf16_f32 v180, v136, v137
    v_cvt_pk_bf16_f32 v181, v138, v139
    v_cvt_pk_bf16_f32 v182, v140, v141
    v_cvt_pk_bf16_f32 v183, v142, v143
    v_cvt_pk_bf16_f32 v184, v144, v145
    v_cvt_pk_bf16_f32 v185, v146, v147
    v_cvt_pk_bf16_f32 v186, v148, v149
    v_cvt_pk_bf16_f32 v187, v150, v151
    v_cvt_pk_bf16_f32 v188, v152, v153
    v_cvt_pk_bf16_f32 v189, v154, v155
    v_cvt_pk_bf16_f32 v190, v156, v157
    v_cvt_pk_bf16_f32 v191, v158, v159
    s_waitcnt vmcnt(21)
    v_mfma_f32_32x32x16_bf16 a[32:47], v[64:67], a[128:131], 0
    buffer_load_dwordx4 v[120:123], v35, s[20:23], s38 offen offset:0 sc1
    v_mfma_f32_32x32x16_bf16 a[48:63], v[64:67], a[144:147], 0
    buffer_store_dwordx4 v[176:179], v0, s[20:23], s65 offen offset:0 sc1
    s_waitcnt vmcnt(22)
    v_mfma_f32_32x32x16_bf16 a[64:79], v[68:71], a[128:131], 0
    buffer_load_dwordx4 v[124:127], v35, s[20:23], s36 offen offset:1024 sc1
    v_mfma_f32_32x32x16_bf16 a[80:95], v[68:71], a[144:147], 0
    buffer_store_dwordx4 v[180:183], v0, s[20:23], s65 offen offset:1024 sc1
    s_waitcnt vmcnt(23)
    v_mfma_f32_32x32x16_bf16 a[96:111], v[72:75], a[128:131], 0
    buffer_load_dwordx4 v[64:67], v35, s[20:23], s37 offen offset:1024 sc1
    v_mfma_f32_32x32x16_bf16 a[112:127], v[72:75], a[144:147], 0
    buffer_store_dwordx4 v[184:187], v0, s[20:23], s65 offen offset:2048 sc1
    s_waitcnt vmcnt(24)
    v_mfma_f32_32x32x16_bf16 a[32:47], v[76:79], a[132:135], a[32:47]
    buffer_load_dwordx4 v[68:71], v35, s[20:23], s38 offen offset:1024 sc1
    v_mfma_f32_32x32x16_bf16 a[48:63], v[76:79], a[148:151], a[48:63]
    buffer_store_dwordx4 v[188:191], v0, s[20:23], s65 offen offset:3072 sc1
    s_waitcnt vmcnt(25)
    v_mfma_f32_32x32x16_bf16 a[64:79], v[80:83], a[132:135], a[64:79]
    buffer_load_dwordx4 v[72:75], v35, s[20:23], s36 offen offset:2048 sc1
    v_mfma_f32_32x32x16_bf16 a[80:95], v[80:83], a[148:151], a[80:95]
    s_waitcnt vmcnt(25)
    v_mfma_f32_32x32x16_bf16 a[96:111], v[84:87], a[132:135], a[96:111]
    buffer_load_dwordx4 v[76:79], v35, s[20:23], s37 offen offset:2048 sc1
    v_mfma_f32_32x32x16_bf16 a[112:127], v[84:87], a[148:151], a[112:127]
    s_waitcnt vmcnt(25)
    v_mfma_f32_32x32x16_bf16 a[32:47], v[88:91], a[136:139], a[32:47]
    buffer_load_dwordx4 v[80:83], v35, s[20:23], s38 offen offset:2048 sc1
    v_mfma_f32_32x32x16_bf16 a[48:63], v[88:91], a[152:155], a[48:63]
    s_waitcnt vmcnt(25)
    v_mfma_f32_32x32x16_bf16 a[64:79], v[92:95], a[136:139], a[64:79]
    buffer_load_dwordx4 v[84:87], v35, s[20:23], s36 offen offset:3072 sc1
    v_mfma_f32_32x32x16_bf16 a[80:95], v[92:95], a[152:155], a[80:95]
    s_waitcnt vmcnt(25)
    v_mfma_f32_32x32x16_bf16 a[96:111], v[96:99], a[136:139], a[96:111]
    buffer_load_dwordx4 v[88:91], v35, s[20:23], s37 offen offset:3072 sc1
    v_lshrrev_b32 v2, 3, v1
    v_mfma_f32_32x32x16_bf16 a[112:127], v[96:99], a[152:155], a[112:127]
    v_bfe_u32 v3, v1, 4, 1
    v_lshlrev_b32 v3, 2, v3
    v_and_b32 v4, 7, v1
    s_waitcnt vmcnt(25)
    v_mfma_f32_32x32x16_bf16 a[32:47], v[100:103], a[140:143], a[32:47]
    buffer_load_dwordx4 v[92:95], v35, s[20:23], s38 offen offset:3072 sc1
    v_xor_b32 v3, v3, v4
    v_mfma_f32_32x32x16_bf16 a[48:63], v[100:103], a[156:159], a[48:63]
    v_lshlrev_b32 v3, 4, v3
    v_lshl_add_u32 v16, v2, 10, v3
    v_add_u32 v17, 7168, v16
    s_waitcnt vmcnt(25)
    v_mfma_f32_32x32x16_bf16 a[64:79], v[104:107], a[140:143], a[64:79]
    s_andn2_b32 s68, 3840, s76
    s_cbranch_scc1 Ls_35
Lb_36:
    s_add_u32 s8, s44, 16384
    s_add_u32 s9, s45, 16384
    s_add_u32 s10, s46, 16384
    buffer_load_dwordx4 v[96:99], v35, s[20:23], s8 offen offset:0 sc1
    v_mfma_f32_32x32x16_bf16 a[80:95], v[104:107], a[156:159], a[80:95]
    v_add_u32 v18, 14336, v16
    v_add_u32 v19, 21504, v16
    s_lshr_b32 s12, s48, 1
    s_and_b32 s13, s48, 1
    s_waitcnt vmcnt(25)
    v_mfma_f32_32x32x16_bf16 a[96:111], v[108:111], a[140:143], a[96:111]
    buffer_load_dwordx4 v[100:103], v35, s[20:23], s9 offen offset:0 sc1
    s_lshl_b32 s14, s67, 7
    v_mfma_f32_32x32x16_bf16 a[112:127], v[108:111], a[156:159], a[112:127]
    s_lshl_b32 s72, s12, 18
    s_add_u32 s15, s72, s14
    s_mul_i32 s72, s12, 360448
    s_waitcnt vmcnt(25)
    v_mfma_f32_32x32x16_bf16 a[32:47], v[112:115], a[160:163], a[32:47]
    buffer_load_dwordx4 v[104:107], v35, s[20:23], s10 offen offset:0 sc1
    s_add_u32 s75, s72, s14
    v_mfma_f32_32x32x16_bf16 a[48:63], v[112:115], a[176:179], a[48:63]
    s_lshl_b32 s72, s13, 16
    s_add_u32 s15, s15, s72
    s_add_u32 s4, s75, s72
    s_waitcnt vmcnt(25)
    v_mfma_f32_32x32x16_bf16 a[64:79], v[116:119], a[160:163], a[64:79]
    buffer_load_dwordx4 v[108:111], v35, s[20:23], s8 offen offset:1024 sc1
    s_add_u32 s75, s4, s72
    v_mfma_f32_32x32x16_bf16 a[80:95], v[116:119], a[176:179], a[80:95]
    s_lshl_b32 s7, s39, 15
    s_lshl_b32 s72, s12, 14
    s_add_u32 s7, s7, s72
    s_waitcnt vmcnt(17)
    v_mfma_f32_32x32x16_bf16 a[96:111], v[120:123], a[160:163], a[96:111]
    buffer_load_dwordx4 v[112:115], v35, s[20:23], s9 offen offset:1024 sc1
    s_add_u32 s7, s7, 10485760
    v_mfma_f32_32x32x16_bf16 a[112:127], v[120:123], a[176:179], a[112:127]
    s_mul_i32 s41, s39, 45056
    s_mul_i32 s72, s12, 22528
    s_add_u32 s41, s41, s72
    s_waitcnt vmcnt(16)
    v_mfma_f32_32x32x16_bf16 a[32:47], v[124:127], a[164:167], a[32:47]
    buffer_load_dwordx4 v[116:119], v35, s[20:23], s10 offen offset:1024 sc1
    s_add_u32 s41, s41, 7340032
    v_mfma_f32_32x32x16_bf16 a[48:63], v[124:127], a[180:183], a[48:63]
    s_lshl_b32 s79, s48, 13
    v_accvgpr_read_b32 v32, a248
    v_add_u32 v6, s54, v0
    s_waitcnt vmcnt(15)
    v_mfma_f32_32x32x16_bf16 a[64:79], v[64:67], a[164:167], a[64:79]
    buffer_load_dwordx4 v[120:123], v35, s[20:23], s8 offen offset:2048 sc1
    v_lshlrev_b32 v32, 16, v32
    v_mfma_f32_32x32x16_bf16 a[80:95], v[64:67], a[180:183], a[80:95]
    v_xor_b32 v7, 32768, v6
    v_xor_b32 v8, 65536, v6
    v_xor_b32 v9, 98304, v6
    s_waitcnt vmcnt(14)
    v_mfma_f32_32x32x16_bf16 a[96:111], v[68:71], a[164:167], a[96:111]
    buffer_load_dwordx4 v[124:127], v35, s[20:23], s9 offen offset:2048 sc1
    v_bfe_u32 v2, v1, 2, 2
    v_mfma_f32_32x32x16_bf16 a[112:127], v[68:71], a[180:183], a[112:127]
    v_lshlrev_b32 v2, 7, v2
    v_bfe_u32 v3, v1, 3, 1
    v_xor_b32 v3, s12, v3
    s_waitcnt vmcnt(13)
    v_mfma_f32_32x32x16_bf16 a[32:47], v[72:75], a[168:171], a[32:47]
    buffer_load_dwordx4 v[64:67], v35, s[20:23], s10 offen offset:2048 sc1
    v_lshl_add_u32 v2, v3, 6, v2
    v_mfma_f32_32x32x16_bf16 a[48:63], v[72:75], a[184:187], a[48:63]
    v_mov_b32 v14, s53
    buffer_store_dword v14, v61, s[20:23], s83 offen sc1
    v_bfe_u32 v3, v1, 4, 1
    s_waitcnt vmcnt(14)
    v_mfma_f32_32x32x16_bf16 a[64:79], v[76:79], a[168:171], a[64:79]
    buffer_load_dwordx4 v[68:71], v35, s[20:23], s8 offen offset:3072 sc1
    v_lshl_add_u32 v2, v3, 5, v2
    v_mfma_f32_32x32x16_bf16 a[80:95], v[76:79], a[184:187], a[80:95]
    v_and_b32 v3, 3, v1
    v_lshl_add_u32 v2, v3, 3, v2
    s_lshl_b32 s72, s12, 16
    v_lshl_add_u32 v3, v57, 11, v2
    v_add_u32 v36, s72, v3
    s_waitcnt vmcnt(14)
    v_mfma_f32_32x32x16_bf16 a[96:111], v[80:83], a[168:171], a[96:111]
    buffer_load_dwordx4 v[72:75], v35, s[20:23], s9 offen offset:3072 sc1
    v_xor_b32 v37, 64, v36
    v_mfma_f32_32x32x16_bf16 a[112:127], v[80:83], a[184:187], a[112:127]
    v_lshl_add_u32 v3, v57, 9, v2
    v_add_u32 v28, s72, v3
    v_xor_b32 v29, 64, v28
    s_waitcnt vmcnt(14)
    v_mfma_f32_32x32x16_bf16 a[32:47], v[84:87], a[172:175], a[32:47]
    buffer_load_dwordx4 v[76:79], v35, s[20:23], s10 offen offset:3072 sc1
    s_lshl_b32 s72, s12, 14
    v_mfma_f32_32x32x16_bf16 a[48:63], v[84:87], a[188:191], a[48:63]
    s_add_u32 s72, s72, 131072
    v_add_u32 v38, s72, v3
    v_xor_b32 v39, 64, v38
    s_waitcnt vmcnt(14)
    v_mfma_f32_32x32x16_bf16 a[64:79], v[88:91], a[172:175], a[64:79]
    s_andn2_b32 s68, 61440, s76
    s_cbranch_scc1 Ls_37
Lb_38:
    s_add_u32 s36, s44, 24576
    s_add_u32 s37, s45, 24576
    s_add_u32 s38, s46, 24576
    buffer_load_dwordx4 v[80:83], v35, s[20:23], s36 offen offset:0 sc1
    v_mfma_f32_32x32x16_bf16 a[80:95], v[88:91], a[188:191], a[80:95]
    v_and_b32 v41, 3, v1
    v_lshlrev_b32 v41, 7, v41
    s_lshl_b32 s5, s39, 10
    s_lshl_b32 s72, s12, 9
    s_waitcnt vmcnt(14)
    v_mfma_f32_32x32x16_bf16 a[96:111], v[92:95], a[172:175], a[96:111]
    buffer_load_dwordx4 v[84:87], v35, s[20:23], s37 offen offset:0 sc1
    s_add_u32 s5, s5, s72
    v_mfma_f32_32x32x16_bf16 a[112:127], v[92:95], a[188:191], a[112:127]
    s_add_u32 s5, s5, 12845056
    s_lshl_b32 s82, s66, 12
    s_add_u32 s82, s82, 12976128
    s_waitcnt vmcnt(14)
    v_mfma_f32_32x32x16_bf16 a[32:47], v[96:99], a[192:195], a[32:47]
    buffer_load_dwordx4 v[88:91], v35, s[20:23], s38 offen offset:0 sc1
    s_lshl_b32 s72, s67, 2
    v_mfma_f32_32x32x16_bf16 a[48:63], v[96:99], a[208:211], a[48:63]
    s_add_u32 s72, s72, s48
    s_lshl_b32 s72, s72, 7
    s_add_u32 s6, s82, s72
    s_waitcnt vmcnt(14)
    v_mfma_f32_32x32x16_bf16 a[64:79], v[100:103], a[192:195], a[64:79]
    buffer_load_dwordx4 v[92:95], v35, s[20:23], s36 offen offset:1024 sc1
    s_lshl_b32 s72, s13, 7
    v_mfma_f32_32x32x16_bf16 a[80:95], v[100:103], a[208:211], a[80:95]
    s_add_u32 s82, s82, s72
    v_and_b32 v40, 15, v1
    v_lshlrev_b32 v40, 8, v40
    s_waitcnt vmcnt(14)
    v_mfma_f32_32x32x16_bf16 a[96:111], v[104:107], a[192:195], a[96:111]
    buffer_load_dwordx4 v[96:99], v35, s[20:23], s37 offen offset:1024 sc1
    v_mfma_f32_32x32x16_bf16 a[112:127], v[104:107], a[208:211], a[112:127]
    s_waitcnt vmcnt(14)
    v_mfma_f32_32x32x16_bf16 a[32:47], v[108:111], a[196:199], a[32:47]
    buffer_load_dwordx4 v[100:103], v35, s[20:23], s38 offen offset:1024 sc1
    v_mfma_f32_32x32x16_bf16 a[48:63], v[108:111], a[212:215], a[48:63]
    s_waitcnt vmcnt(14)
    v_mfma_f32_32x32x16_bf16 a[64:79], v[112:115], a[196:199], a[64:79]
    buffer_load_dwordx4 v[104:107], v35, s[20:23], s36 offen offset:2048 sc1
    v_mfma_f32_32x32x16_bf16 a[80:95], v[112:115], a[212:215], a[80:95]
    s_waitcnt vmcnt(14)
    v_mfma_f32_32x32x16_bf16 a[96:111], v[116:119], a[196:199], a[96:111]
    buffer_load_dwordx4 v[108:111], v35, s[20:23], s37 offen offset:2048 sc1
    v_mfma_f32_32x32x16_bf16 a[112:127], v[116:119], a[212:215], a[112:127]
    s_waitcnt vmcnt(14)
    v_mfma_f32_32x32x16_bf16 a[32:47], v[120:123], a[200:203], a[32:47]
    buffer_load_dwordx4 v[112:115], v35, s[20:23], s38 offen offset:2048 sc1
    v_mfma_f32_32x32x16_bf16 a[48:63], v[120:123], a[216:219], a[48:63]
    s_waitcnt vmcnt(14)
    v_mfma_f32_32x32x16_bf16 a[64:79], v[124:127], a[200:203], a[64:79]
    buffer_load_dwordx4 v[116:119], v35, s[20:23], s36 offen offset:3072 sc1
    v_mfma_f32_32x32x16_bf16 a[80:95], v[124:127], a[216:219], a[80:95]
    s_waitcnt vmcnt(14)
    v_mfma_f32_32x32x16_bf16 a[96:111], v[64:67], a[200:203], a[96:111]
    buffer_load_dwordx4 v[120:123], v35, s[20:23], s37 offen offset:3072 sc1
    v_mfma_f32_32x32x16_bf16 a[112:127], v[64:67], a[216:219], a[112:127]
    s_waitcnt vmcnt(13)
    v_mfma_f32_32x32x16_bf16 a[32:47], v[68:71], a[204:207], a[32:47]
    buffer_load_dwordx4 v[124:127], v35, s[20:23], s38 offen offset:3072 sc1
    v_mfma_f32_32x32x16_bf16 a[48:63], v[68:71], a[220:223], a[48:63]
    s_waitcnt vmcnt(13)
    v_mfma_f32_32x32x16_bf16 a[64:79], v[72:75], a[204:207], a[64:79]
    s_andn2_b32 s68, 983040, s76
    s_cbranch_scc1 Ls_39
Lb_40:
    s_add_u32 s8, s44, 32768
    s_add_u32 s9, s45, 32768
    s_add_u32 s10, s46, 32768
    buffer_load_dwordx4 v[64:67], v35, s[20:23], s8 offen offset:0 sc1
    v_mfma_f32_32x32x16_bf16 a[80:95], v[72:75], a[220:223], a[80:95]
    s_waitcnt vmcnt(13)
    v_mfma_f32_32x32x16_bf16 a[96:111], v[76:79], a[204:207], a[96:111]
    buffer_load_dwordx4 v[68:71], v35, s[20:23], s9 offen offset:0 sc1
    v_mfma_f32_32x32x16_bf16 a[112:127], v[76:79], a[220:223], a[112:127]
    s_waitcnt vmcnt(13)
    v_mfma_f32_32x32x16_bf16 a[32:47], v[80:83], a[224:227], a[32:47]
    buffer_load_dwordx4 v[72:75], v35, s[20:23], s10 offen offset:0 sc1
    v_mfma_f32_32x32x16_bf16 a[48:63], v[80:83], a[0:3], a[48:63]
    s_waitcnt vmcnt(13)
    v_mfma_f32_32x32x16_bf16 a[64:79], v[84:87], a[224:227], a[64:79]
    buffer_load_dwordx4 v[76:79], v35, s[20:23], s8 offen offset:1024 sc1
    v_mfma_f32_32x32x16_bf16 a[80:95], v[84:87], a[0:3], a[80:95]
    s_waitcnt vmcnt(13)
    v_mfma_f32_32x32x16_bf16 a[96:111], v[88:91], a[224:227], a[96:111]
    buffer_load_dwordx4 v[80:83], v35, s[20:23], s9 offen offset:1024 sc1
    v_mfma_f32_32x32x16_bf16 a[112:127], v[88:91], a[0:3], a[112:127]
    s_waitcnt vmcnt(13)
    v_mfma_f32_32x32x16_bf16 a[32:47], v[92:95], a[228:231], a[32:47]
    buffer_load_dwordx4 v[84:87], v35, s[20:23], s10 offen offset:1024 sc1
    v_mfma_f32_32x32x16_bf16 a[48:63], v[92:95], a[4:7], a[48:63]
    s_waitcnt vmcnt(13)
    v_mfma_f32_32x32x16_bf16 a[64:79], v[96:99], a[228:231], a[64:79]
    buffer_load_dwordx4 v[88:91], v35, s[20:23], s8 offen offset:2048 sc1
    v_mfma_f32_32x32x16_bf16 a[80:95], v[96:99], a[4:7], a[80:95]
    v_min_u32 v2, 2, v1
    v_lshlrev_b32 v2, 1, v2
    v_add_u32 v2, s84, v2
    v_max_i32 v2, 0, v2
    v_lshrrev_b32 v2, 3, v2
    v_min_u32 v2, 5, v2
    v_lshlrev_b32 v26, 13, v2
    s_lshl_b32 s64, s39, 7
    s_add_u32 s64, s64, 12713984
    buffer_load_dword v27, v26, s[20:23], s64 offen sc1
    s_waitcnt vmcnt(14)
    v_mfma_f32_32x32x16_bf16 a[96:111], v[100:103], a[228:231], a[96:111]
    buffer_load_dwordx4 v[92:95], v35, s[20:23], s9 offen offset:2048 sc1
    v_mfma_f32_32x32x16_bf16 a[112:127], v[100:103], a[4:7], a[112:127]
    s_waitcnt vmcnt(14)
    v_mfma_f32_32x32x16_bf16 a[32:47], v[104:107], a[232:235], a[32:47]
    buffer_load_dwordx4 v[96:99], v35, s[20:23], s10 offen offset:2048 sc1
    v_mfma_f32_32x32x16_bf16 a[48:63], v[104:107], a[8:11], a[48:63]
    s_waitcnt vmcnt(14)
    v_mfma_f32_32x32x16_bf16 a[64:79], v[108:111], a[232:235], a[64:79]
    buffer_load_dwordx4 v[100:103], v35, s[20:23], s8 offen offset:3072 sc1
    v_mfma_f32_32x32x16_bf16 a[80:95], v[108:111], a[8:11], a[80:95]
    s_waitcnt vmcnt(14)
    v_mfma_f32_32x32x16_bf16 a[96:111], v[112:115], a[232:235], a[96:111]
    buffer_load_dwordx4 v[104:107], v35, s[20:23], s9 offen offset:3072 sc1
    v_mfma_f32_32x32x16_bf16 a[112:127], v[112:115], a[8:11], a[112:127]
    s_waitcnt vmcnt(14)
    v_mfma_f32_32x32x16_bf16 a[32:47], v[116:119], a[236:239], a[32:47]
    buffer_load_dwordx4 v[108:111], v35, s[20:23], s10 offen offset:3072 sc1
    v_mfma_f32_32x32x16_bf16 a[48:63], v[116:119], a[12:15], a[48:63]
    s_waitcnt vmcnt(14)
    v_mfma_f32_32x32x16_bf16 a[64:79], v[120:123], a[236:239], a[64:79]
    s_andn2_b32 s68, 15728640, s76
    s_cbranch_scc1 Ls_41
Lb_42:
    s_add_u32 s36, s44, 40960
    s_add_u32 s37, s45, 40960
    s_add_u32 s38, s46, 40960
    buffer_load_dwordx4 v[112:115], v35, s[20:23], s36 offen offset:0 sc1
    v_mfma_f32_32x32x16_bf16 a[80:95], v[120:123], a[12:15], a[80:95]
    ds_read_b128 v[140:143], v20 offset:16384
    s_waitcnt vmcnt(14)
    v_mfma_f32_32x32x16_bf16 a[96:111], v[124:127], a[236:239], a[96:111]
    buffer_load_dwordx4 v[116:119], v35, s[20:23], s37 offen offset:0 sc1
    v_mfma_f32_32x32x16_bf16 a[112:127], v[124:127], a[12:15], a[112:127]
    s_waitcnt vmcnt(14) lgkmcnt(0)
    v_mfma_f32_32x32x16_bf16 a[32:47], v[64:67], a[16:19], a[32:47]
    buffer_load_dwordx4 v[120:123], v35, s[20:23], s38 offen offset:0 sc1
    v_mfma_f32_32x32x16_bf16 a[48:63], v[64:67], v[140:143], a[48:63]
    v_and_b32 v152, 15, v1
    v_lshlrev_b32 v152, 9, v152
    s_lshl_b32 s62, s50, 6
    s_add_u32 s62, s62, s48
    s_lshl_b32 s62, s62, 7
    s_add_u32 s62, s62, 12779520
    buffer_load_dword v153, v152, s[20:23], s62 offen sc1
    s_waitcnt vmcnt(15)
    v_mfma_f32_32x32x16_bf16 a[64:79], v[68:71], a[16:19], a[64:79]
    buffer_load_dwordx4 v[124:127], v35, s[20:23], s36 offen offset:1024 sc1
    ds_read_b128 v[148:151], v21 offset:16384
    v_mfma_f32_32x32x16_bf16 a[80:95], v[68:71], v[140:143], a[80:95]
    s_waitcnt vmcnt(15)
    v_mfma_f32_32x32x16_bf16 a[96:111], v[72:75], a[16:19], a[96:111]
    ds_read_b128 a[192:195], v20 offset:24576
    buffer_load_dwordx4 v[64:67], v35, s[20:23], s37 offen offset:1024 sc1
    v_mfma_f32_32x32x16_bf16 a[112:127], v[72:75], v[140:143], a[112:127]
    s_waitcnt vmcnt(15) lgkmcnt(1)
    v_mfma_f32_32x32x16_bf16 a[32:47], v[76:79], a[20:23], a[32:47]
    ds_read_b128 a[196:199], v21 offset:24576
    buffer_load_dwordx4 v[68:71], v35, s[20:23], s38 offen offset:1024 sc1
    v_mfma_f32_32x32x16_bf16 a[48:63], v[76:79], v[148:151], a[48:63]
    s_waitcnt vmcnt(15)
    v_mfma_f32_32x32x16_bf16 a[64:79], v[80:83], a[20:23], a[64:79]
    buffer_load_dwordx4 v[72:75], v35, s[20:23], s36 offen offset:2048 sc1
    ds_read_b128 v[132:135], v22 offset:16384
    v_mfma_f32_32x32x16_bf16 a[80:95], v[80:83], v[148:151], a[80:95]
    ds_read_b128 a[200:203], v22 offset:24576
    s_waitcnt vmcnt(15)
    v_mfma_f32_32x32x16_bf16 a[96:111], v[84:87], a[20:23], a[96:111]
    ds_read_b128 a[204:207], v23 offset:24576
    buffer_load_dwordx4 v[76:79], v35, s[20:23], s37 offen offset:2048 sc1
    v_mfma_f32_32x32x16_bf16 a[112:127], v[84:87], v[148:151], a[112:127]
    s_waitcnt vmcnt(15) lgkmcnt(2)
    v_mfma_f32_32x32x16_bf16 a[32:47], v[88:91], a[24:27], a[32:47]
    ds_read_b128 a[208:211], v20 offset:28672
    buffer_load_dwordx4 v[80:83], v35, s[20:23], s38 offen offset:2048 sc1
    v_mfma_f32_32x32x16_bf16 a[48:63], v[88:91], v[132:135], a[48:63]
    s_waitcnt vmcnt(6)
    v_cmp_ne_u32 vcc, s53, v153
    s_nop 1
    s_and_b32 s68, vcc_lo, 65535
    s_cbranch_scc1 Ls_43
Lb_44:
    v_cmp_gt_u32 vcc, 8, v1
    s_lshl_b32 s69, s50, 2
    s_add_u32 s69, s69, s48
    s_mul_i32 s69, s69, 2176
    s_add_u32 s69, s69, 65536
    v_cndmask_b32 v153, v60, v0, vcc
    buffer_load_dwordx4 v[156:159], v0, s[20:23], s69 offen sc1
    buffer_load_dwordx4 v[160:163], v0, s[20:23], s69 offen offset:1024 sc1
    buffer_load_dwordx4 v[164:167], v153, s[20:23], s69 offen offset:2048 sc1
    v_mfma_f32_32x32x16_bf16 a[64:79], v[92:95], a[24:27], a[64:79]
    buffer_load_dwordx4 v[84:87], v35, s[20:23], s36 offen offset:3072 sc1
    v_lshrrev_b32 v152, 3, v1
    ds_read_b128 v[140:143], v23 offset:16384
    v_mfma_f32_32x32x16_bf16 a[80:95], v[92:95], v[132:135], a[80:95]
    ds_read_b128 a[212:215], v21 offset:28672
    v_mul_u32_u24 v152, 80, v152
    v_and_b32 v153, 7, v1
    v_lshl_add_u32 v152, v153, 3, v152
    v_add_u32 v152, s3, v152
    v_add_u32 v152, 147456, v152
    v_mfma_f32_32x32x16_bf16 a[96:111], v[96:99], a[24:27], a[96:111]
    ds_read_b128 a[216:219], v22 offset:28672
    buffer_load_dwordx4 v[88:91], v35, s[20:23], s37 offen offset:3072 sc1
    v_bfe_u32 v153, v1, 3, 2
    v_mfma_f32_32x32x16_bf16 a[112:127], v[96:99], v[132:135], a[112:127]
    v_lshlrev_b32 v153, 2, v153
    v_and_b32 v154, 3, v1
    s_waitcnt lgkmcnt(2)
    v_mfma_f32_32x32x16_bf16 a[32:47], v[100:103], a[28:31], a[32:47]
    ds_read_b128 a[220:223], v23 offset:28672
    buffer_load_dwordx4 v[92:95], v35, s[20:23], s38 offen offset:3072 sc1
    v_mfma_f32_32x32x16_bf16 a[48:63], v[100:103], v[140:143], a[48:63]
    v_or_b32 v153, v153, v154
    v_bfe_u32 v154, v1, 2, 1
    v_cmp_eq_u32 vcc, v154, v57
    v_lshlrev_b32 v154, 11, v57
    v_add_u32 v154, 147456, v154
    v_cndmask_b32 v153, 17, v153, vcc
    v_mfma_f32_32x32x16_bf16 a[64:79], v[104:107], a[28:31], a[64:79]
    ds_read_b128 v[144:147], v20 offset:20480
    s_andn2_b32 s68, 251658240, s76
    s_cbranch_scc1 Ls_45
Lb_46:
    s_add_u32 s8, s44, 49152
    s_add_u32 s9, s45, 49152
    s_add_u32 s10, s46, 49152
    buffer_load_dwordx4 v[96:99], v35, s[20:23], s8 offen offset:0 sc1
    v_mfma_f32_32x32x16_bf16 a[80:95], v[104:107], v[140:143], a[80:95]
    ds_read_b128 v[148:151], v20 offset:8192
    v_mul_u32_u24 v153, 80, v153
    ds_read_b128 a[224:227], v20 offset:0
    v_add_u32 v153, v153, v154
    v_add_u32 v154, 1280, v154
    v_mfma_f32_32x32x16_bf16 a[96:111], v[108:111], a[28:31], a[96:111]
    ds_read_b128 a[228:231], v21 offset:0
    buffer_load_dwordx4 v[100:103], v35, s[20:23], s8 offen offset:1024 sc1
    v_mfma_f32_32x32x16_bf16 a[112:127], v[108:111], v[140:143], a[112:127]
    s_waitcnt lgkmcnt(2)
    v_mfma_f32_32x32x16_bf16 a[32:47], v[112:115], v[144:147], a[32:47]
    ds_read_b128 a[232:235], v22 offset:0
    buffer_load_dwordx4 v[104:107], v35, s[20:23], s8 offen offset:2048 sc1
    v_mfma_f32_32x32x16_bf16 a[48:63], v[112:115], v[148:151], a[48:63]
    v_mfma_f32_32x32x16_bf16 a[64:79], v[116:119], v[144:147], a[64:79]
    ds_read_b128 v[128:131], v21 offset:20480
    buffer_load_dwordx4 v[108:111], v35, s[20:23], s8 offen offset:3072 sc1
    ds_read_b128 v[132:135], v21 offset:8192
    v_mfma_f32_32x32x16_bf16 a[80:95], v[116:119], v[148:151], a[80:95]
    ds_read_b128 a[236:239], v23 offset:0
    v_mfma_f32_32x32x16_bf16 a[96:111], v[120:123], v[144:147], a[96:111]
    ds_read_b128 a[0:3], v20 offset:4096
    s_andn2_b32 s68, 4026531840, s76
    s_cbranch_scc1 Ls_47
Lb_48:
    s_add_u32 s36, s44, 57344
    s_add_u32 s37, s45, 57344
    s_add_u32 s38, s46, 57344
    buffer_load_dwordx4 v[112:115], v35, s[20:23], s36 offen offset:0 sc1
    v_mfma_f32_32x32x16_bf16 a[112:127], v[120:123], v[148:151], a[112:127]
    s_waitcnt vmcnt(16) lgkmcnt(2)
    v_mfma_f32_32x32x16_bf16 a[32:47], v[124:127], v[128:131], a[32:47]
    ds_read_b128 a[4:7], v21 offset:4096
    buffer_load_dwordx4 v[116:119], v35, s[20:23], s36 offen offset:1024 sc1
    v_mfma_f32_32x32x16_bf16 a[48:63], v[124:127], v[132:135], a[48:63]
    s_waitcnt vmcnt(16)
    v_mfma_f32_32x32x16_bf16 a[64:79], v[64:67], v[128:131], a[64:79]
    ds_read_b128 v[136:139], v22 offset:20480
    buffer_load_dwordx4 v[120:123], v35, s[20:23], s36 offen offset:2048 sc1
    v_mfma_f32_32x32x16_bf16 a[80:95], v[64:67], v[132:135], a[80:95]
    ds_read_b128 v[140:143], v22 offset:8192
    ds_read_b128 a[8:11], v22 offset:4096
    s_waitcnt vmcnt(16)
    v_mfma_f32_32x32x16_bf16 a[96:111], v[68:71], v[128:131], a[96:111]
    ds_read_b128 a[12:15], v23 offset:4096
    buffer_load_dwordx4 v[124:127], v35, s[20:23], s36 offen offset:3072 sc1
    v_mfma_f32_32x32x16_bf16 a[112:127], v[68:71], v[132:135], a[112:127]
    s_waitcnt vmcnt(11)
    v_cvt_pk_bf16_f32 v156, v156, v157
    v_cvt_pk_bf16_f32 v157, v158, v159
    ds_write_b64 v152, v[156:157] offset:0
    v_cvt_pk_bf16_f32 v160, v160, v161
    v_cvt_pk_bf16_f32 v161, v162, v163
    ds_write_b64 v152, v[160:161] offset:640
    s_waitcnt lgkmcnt(4)
    v_mfma_f32_32x32x16_bf16 a[32:47], v[72:75], v[136:139], a[32:47]
    buffer_load_dwordx4 v[64:67], v35, s[20:23], s9 offen offset:0 sc1
    v_cvt_pk_bf16_f32 v164, v164, v165
    v_cvt_pk_bf16_f32 v165, v166, v167
    ds_write_b64 v152, v[164:165] offset:1280
    v_mfma_f32_32x32x16_bf16 a[48:63], v[72:75], v[140:143], a[48:63]
    v_mfma_f32_32x32x16_bf16 a[64:79], v[76:79], v[136:139], a[64:79]
    ds_read_b128 v[144:147], v23 offset:20480
    buffer_load_dwordx4 v[68:71], v35, s[20:23], s9 offen offset:1024 sc1
    s_waitcnt lgkmcnt(1)
    s_barrier
    v_mfma_f32_32x32x16_bf16 a[80:95], v[76:79], v[140:143], a[80:95]
    ds_read_b128 v[148:151], v23 offset:8192
    ds_read_b128 v[156:159], v153 offset:0
    ds_read_b128 v[160:163], v153 offset:16
    ds_read_b128 v[164:167], v153 offset:32
    ds_read_b128 v[168:171], v153 offset:48
    v_mfma_f32_32x32x16_bf16 a[96:111], v[80:83], v[136:139], a[96:111]
    buffer_load_dwordx4 v[72:75], v35, s[20:23], s9 offen offset:2048 sc1
    ds_read_b128 v[172:175], v153 offset:4096
    ds_read_b128 v[176:179], v153 offset:4112
    v_mfma_f32_32x32x16_bf16 a[112:127], v[80:83], v[140:143], a[112:127]
    ds_read_b128 v[180:183], v153 offset:4128
    ds_read_b128 v[184:187], v153 offset:4144
    s_waitcnt vmcnt(13) lgkmcnt(8)
    v_mfma_f32_32x32x16_bf16 a[32:47], v[84:87], v[144:147], a[32:47]
    buffer_load_dwordx4 v[76:79], v35, s[20:23], s9 offen offset:3072 sc1
    ds_read_b128 v[188:191], v154 offset:0
    v_mfma_f32_32x32x16_bf16 a[48:63], v[84:87], v[148:151], a[48:63]
    ds_read_b128 v[192:195], v154 offset:16
    ds_read_b128 v[196:199], v154 offset:32
    ds_read_b128 v[200:203], v154 offset:48
    s_waitcnt vmcnt(13)
    v_mfma_f32_32x32x16_bf16 a[64:79], v[88:91], v[144:147], a[64:79]
    buffer_load_dwordx4 v[80:83], v35, s[20:23], s37 offen offset:0 sc1
    ds_read_b128 v[204:207], v154 offset:4096
    v_mfma_f32_32x32x16_bf16 a[80:95], v[88:91], v[148:151], a[80:95]
    v_cmp_ne_u32 vcc, s53, v27
    s_nop 1
    s_and_b32 s68, vcc_lo, 7
    s_cbranch_scc1 Ls_49
Lb_50:
    s_mul_i32 s71, s39, 44
    s_add_u32 s71, s71, s84
    s_lshl_b32 s58, s71, 10
    s_add_u32 s71, s58, 4194304
    buffer_load_dwordx4 v[44:47], v0, s[20:23], s71 offen sc1
    s_waitcnt vmcnt(14)
    v_mfma_f32_32x32x16_bf16 a[96:111], v[92:95], v[144:147], a[96:111]
    buffer_load_dwordx4 v[84:87], v35, s[20:23], s37 offen offset:1024 sc1
    ds_read_b128 v[208:211], v154 offset:4112
    v_mfma_f32_32x32x16_bf16 a[112:127], v[92:95], v[148:151], a[112:127]
    ds_read_b128 v[212:215], v154 offset:4128
    ds_read_b128 v[216:219], v154 offset:4144
    s_waitcnt vmcnt(14)
    v_mfma_f32_32x32x16_bf16 a[32:47], v[96:99], a[192:195], a[32:47]
    buffer_load_dwordx4 v[88:91], v35, s[20:23], s37 offen offset:2048 sc1
    s_waitcnt lgkmcnt(0)
    v_mov_b32 v152, 0x358637bd
    v_mov_b32 v154, 0x358637bd
    v_dot2c_f32_bf16 v152, v188, v224
    v_dot2c_f32_bf16 v154, v204, v240
    v_dot2c_f32_bf16 v152, v189, v225
    v_dot2c_f32_bf16 v154, v205, v241
    v_dot2c_f32_bf16 v152, v190, v226
    v_dot2c_f32_bf16 v154, v206, v242
    v_dot2c_f32_bf16 v152, v191, v227
    v_dot2c_f32_bf16 v154, v207, v243
    v_dot2c_f32_bf16 v152, v192, v228
    v_dot2c_f32_bf16 v154, v208, v244
    v_dot2c_f32_bf16 v152, v193, v229
    v_dot2c_f32_bf16 v154, v209, v245
    v_dot2c_f32_bf16 v152, v194, v230
    v_dot2c_f32_bf16 v154, v210, v246
    v_dot2c_f32_bf16 v152, v195, v231
    v_dot2c_f32_bf16 v154, v211, v247
    v_dot2c_f32_bf16 v152, v196, v232
    v_dot2c_f32_bf16 v154, v212, v248
    v_dot2c_f32_bf16 v152, v197, v233
    v_dot2c_f32_bf16 v154, v213, v249
    v_dot2c_f32_bf16 v152, v198, v234
    v_dot2c_f32_bf16 v154, v214, v250
    v_dot2c_f32_bf16 v152, v199, v235
    v_dot2c_f32_bf16 v154, v215, v251
    v_dot2c_f32_bf16 v152, v200, v236
    v_dot2c_f32_bf16 v154, v216, v252
    v_dot2c_f32_bf16 v152, v201, v237
    v_dot2c_f32_bf16 v154, v217, v253
    v_dot2c_f32_bf16 v152, v202, v238
    v_dot2c_f32_bf16 v154, v218, v254
    v_dot2c_f32_bf16 v152, v203, v239
    v_dot2c_f32_bf16 v154, v219, v255
    v_mfma_f32_32x32x16_bf16 v[188:203], v[156:159], v[224:227], 0
    v_mfma_f32_32x32x16_bf16 v[188:203], v[160:163], v[228:231], v[188:203]
    v_mfma_f32_32x32x16_bf16 v[188:203], v[164:167], v[232:235], v[188:203]
    v_mfma_f32_32x32x16_bf16 v[188:203], v[168:171], v[236:239], v[188:203]
    v_mfma_f32_32x32x16_bf16 v[204:219], v[172:175], v[240:243], 0
    v_mfma_f32_32x32x16_bf16 v[204:219], v[176:179], v[244:247], v[204:219]
    v_mfma_f32_32x32x16_bf16 v[204:219], v[180:183], v[248:251], v[204:219]
    v_mfma_f32_32x32x16_bf16 v[204:219], v[184:187], v[252:255], v[204:219]
    v_rcp_f32 v152, v152
    v_rcp_f32 v154, v154
    v_mfma_f32_32x32x16_bf16 a[48:63], v[96:99], a[208:211], a[48:63]
    s_add_u32 s71, s58, 4196352
    buffer_load_dwordx4 v[48:51], v0, s[20:23], s71 offen sc1
    s_waitcnt vmcnt(15)
    v_mfma_f32_32x32x16_bf16 a[32:47], v[100:103], a[196:199], a[32:47]
    buffer_load_dwordx4 v[92:95], v35, s[20:23], s37 offen offset:3072 sc1
    s_barrier
    v_mfma_f32_32x32x16_bf16 a[48:63], v[100:103], a[212:215], a[48:63]
    s_waitcnt vmcnt(15)
    v_mfma_f32_32x32x16_bf16 a[32:47], v[104:107], a[200:203], a[32:47]
    buffer_load_dwordx4 v[96:99], v35, s[20:23], s10 offen offset:0 sc1
    v_mul_f32 v188, v188, v152
    v_mfma_f32_32x32x16_bf16 a[48:63], v[104:107], a[216:219], a[48:63]
    s_add_u32 s71, s58, 4198400
    buffer_load_dwordx4 v[52:55], v0, s[20:23], s71 offen sc1
    v_mul_f32 v189, v189, v152
    s_waitcnt vmcnt(16)
    v_mfma_f32_32x32x16_bf16 a[32:47], v[108:111], a[204:207], a[32:47]
    buffer_load_dwordx4 v[100:103], v35, s[20:23], s10 offen offset:1024 sc1
    v_cvt_pk_bf16_f32 v156, v188, v189
    v_mul_f32 v190, v190, v152
    v_mfma_f32_32x32x16_bf16 a[48:63], v[108:111], a[220:223], a[48:63]
    v_mul_f32 v191, v191, v152
    v_cvt_pk_bf16_f32 v157, v190, v191
    v_mul_f32 v192, v192, v152
    v_mul_f32 v193, v193, v152
    v_cvt_pk_bf16_f32 v158, v192, v193
    v_mul_f32 v194, v194, v152
    s_waitcnt vmcnt(16)
    v_mfma_f32_32x32x16_bf16 a[32:47], v[112:115], a[224:227], a[32:47]
    buffer_load_dwordx4 v[104:107], v35, s[20:23], s10 offen offset:2048 sc1
    v_mul_f32 v195, v195, v152
    v_mfma_f32_32x32x16_bf16 a[48:63], v[112:115], a[0:3], a[48:63]
    v_cvt_pk_bf16_f32 v159, v194, v195
    v_mul_f32 v196, v196, v152
    v_mul_f32 v197, v197, v152
    v_cvt_pk_bf16_f32 v160, v196, v197
    v_mul_f32 v198, v198, v152
    v_mul_f32 v199, v199, v152
    s_waitcnt vmcnt(16)
    v_mfma_f32_32x32x16_bf16 a[32:47], v[116:119], a[228:231], a[32:47]
    buffer_load_dwordx4 v[108:111], v35, s[20:23], s10 offen offset:3072 sc1
    v_cvt_pk_bf16_f32 v161, v198, v199
    v_mfma_f32_32x32x16_bf16 a[48:63], v[116:119], a[4:7], a[48:63]
    v_mul_f32 v200, v200, v152
    v_mul_f32 v201, v201, v152
    v_cvt_pk_bf16_f32 v162, v200, v201
    v_mul_f32 v202, v202, v152
    v_mul_f32 v203, v203, v152
    v_cvt_pk_bf16_f32 v163, v202, v203
    s_waitcnt vmcnt(16)
    v_mfma_f32_32x32x16_bf16 a[32:47], v[120:123], a[232:235], a[32:47]
    buffer_load_dwordx4 v[112:115], v35, s[20:23], s38 offen offset:0 sc1
    s_lshl_b32 s69, s63, 15
    s_lshl_b32 s70, s50, 12
    s_add_u32 s69, s69, s70
    s_add_u32 s69, s69, 10485760
    s_lshl_b32 s62, s63, 3
    s_add_u32 s62, s62, s50
    s_lshl_b32 s62, s62, 7
    s_add_u32 s62, s62, 12845056
    buffer_store_dwordx4 v[156:159], v0, s[20:23], s69 offen offset:0 sc1
    buffer_store_dwordx4 v[160:163], v0, s[20:23], s69 offen offset:1024 sc1
    v_mfma_f32_32x32x16_bf16 a[48:63], v[120:123], a[8:11], a[48:63]
    v_mul_f32 v204, v204, v154
    v_mul_f32 v205, v205, v154
    v_cvt_pk_bf16_f32 v164, v204, v205
    v_mul_f32 v206, v206, v154
    v_mul_f32 v207, v207, v154
    v_cvt_pk_bf16_f32 v165, v206, v207
    s_waitcnt vmcnt(18)
    v_mfma_f32_32x32x16_bf16 a[32:47], v[124:127], a[236:239], a[32:47]
    buffer_load_dwordx4 v[116:119], v35, s[20:23], s38 offen offset:1024 sc1
    v_mul_f32 v208, v208, v154
    v_mfma_f32_32x32x16_bf16 a[48:63], v[124:127], a[12:15], a[48:63]
    v_mul_f32 v209, v209, v154
    v_cvt_pk_bf16_f32 v166, v208, v209
    v_mul_f32 v210, v210, v154
    v_mul_f32 v211, v211, v154
    v_cvt_pk_bf16_f32 v167, v210, v211
    v_mul_f32 v212, v212, v154
    s_waitcnt vmcnt(18)
    v_mfma_f32_32x32x16_bf16 a[64:79], v[64:67], a[192:195], a[64:79]
    buffer_load_dwordx4 v[120:123], v35, s[20:23], s38 offen offset:2048 sc1
    v_mul_f32 v213, v213, v154
    v_mfma_f32_32x32x16_bf16 a[80:95], v[64:67], a[208:211], a[80:95]
    v_cvt_pk_bf16_f32 v168, v212, v213
    v_mul_f32 v214, v214, v154
    v_mul_f32 v215, v215, v154
    v_cvt_pk_bf16_f32 v169, v214, v215
    v_mul_f32 v216, v216, v154
    s_waitcnt vmcnt(18)
    v_mfma_f32_32x32x16_bf16 a[64:79], v[68:71], a[196:199], a[64:79]
    buffer_load_dwordx4 v[124:127], v35, s[20:23], s38 offen offset:3072 sc1
    v_mul_f32 v217, v217, v154
    v_mfma_f32_32x32x16_bf16 a[80:95], v[68:71], a[212:215], a[80:95]
    v_cvt_pk_bf16_f32 v170, v216, v217
    v_mul_f32 v218, v218, v154
    v_mul_f32 v219, v219, v154
    v_cvt_pk_bf16_f32 v171, v218, v219
    buffer_store_dwordx4 v[164:167], v0, s[20:23], s69 offen offset:2048 sc1
    buffer_store_dwordx4 v[168:171], v0, s[20:23], s69 offen offset:3072 sc1
    s_waitcnt vmcnt(20)
    v_mfma_f32_32x32x16_bf16 a[64:79], v[72:75], a[200:203], a[64:79]
    ds_write_b128 v6, a[40:43] offset:14336
    s_add_u32 m0, s79, 131072
    v_mfma_f32_32x32x16_bf16 a[80:95], v[72:75], a[216:219], a[80:95]
    s_add_u32 s74, s4, 262144
    buffer_load_dwordx4 v16, s[32:35], s74 offen offset:0 lds
    s_waitcnt vmcnt(20)
    v_mfma_f32_32x32x16_bf16 a[64:79], v[76:79], a[204:207], a[64:79]
    ds_write_b128 v6, a[44:47] offset:15360
    v_mfma_f32_32x32x16_bf16 a[80:95], v[76:79], a[220:223], a[80:95]
    buffer_load_dwordx4 v17, s[32:35], s74 offen offset:1024 lds
    s_waitcnt vmcnt(20)
    v_mfma_f32_32x32x16_bf16 a[64:79], v[80:83], a[224:227], a[64:79]
    ds_write_b128 v6, a[48:51] offset:12288
    s_waitcnt vmcnt(13)
    v_mfma_f32_32x32x16_bf16 a[80:95], v[80:83], a[0:3], a[80:95]
    v_accvgpr_read_b32 v176, a32
    v_accvgpr_read_b32 v177, a33
    v_accvgpr_read_b32 v178, a34
    v_accvgpr_read_b32 v179, a35
    v_accvgpr_read_b32 v180, a36
    v_accvgpr_read_b32 v181, a37
    v_mfma_f32_32x32x16_bf16 a[64:79], v[84:87], a[228:231], a[64:79]
    ds_write_b128 v6, a[52:55] offset:13312
    v_accvgpr_read_b32 v182, a38
    v_accvgpr_read_b32 v183, a39
    v_mfma_f32_32x32x16_bf16 a[80:95], v[84:87], a[4:7], a[80:95]
    buffer_load_dwordx4 v18, s[32:35], s74 offen offset:2048 lds
    v_lshlrev_b32 v208, 16, v44
    v_and_b32 v209, 0xffff0000, v44
    v_mfma_f32_32x32x16_bf16 a[64:79], v[88:91], a[232:235], a[64:79]
    ds_write_b128 v6, a[56:59] offset:16384
    v_lshlrev_b32 v210, 16, v45
    v_and_b32 v211, 0xffff0000, v45
    v_mfma_f32_32x32x16_bf16 a[80:95], v[88:91], a[8:11], a[80:95]
    v_lshlrev_b32 v212, 16, v46
    v_and_b32 v213, 0xffff0000, v46
    v_lshlrev_b32 v214, 16, v47
    v_and_b32 v215, 0xffff0000, v47
    v_add_f32 v176, v176, v32
    v_add_f32 v177, v177, v32
    v_mfma_f32_32x32x16_bf16 a[64:79], v[92:95], a[236:239], a[64:79]
    ds_write_b128 v6, a[60:63] offset:17408
    v_add_f32 v178, v178, v32
    v_add_f32 v179, v179, v32
    v_add_f32 v180, v180, v32
    v_mfma_f32_32x32x16_bf16 a[80:95], v[92:95], a[12:15], a[80:95]
    buffer_load_dwordx4 v19, s[32:35], s74 offen offset:3072 lds
    v_add_f32 v181, v181, v32
    v_add_f32 v182, v182, v32
    v_add_f32 v183, v183, v32
    s_add_u32 s71, s84, 0
    s_add_u32 s70, s58, 7340032
    s_cmp_le_u32 s71, 42
    s_cselect_b32 s70, s70, 1073741824
    v_mfma_f32_32x32x16_bf16 a[96:111], v[96:99], a[192:195], a[96:111]
    s_waitcnt lgkmcnt(0)
    s_barrier
    ds_read_b128 v[184:187], v7 offset:12288
    ds_read_b128 v[188:191], v7 offset:13312
    ds_read_b128 v[192:195], v8 offset:14336
    ds_read_b128 v[196:199], v8 offset:15360
    v_mfma_f32_32x32x16_bf16 a[112:127], v[96:99], a[208:211], a[112:127]
    ds_read_b128 v[200:203], v9 offset:16384
    ds_read_b128 v[204:207], v9 offset:17408
    s_waitcnt vmcnt(14)
    v_mfma_f32_32x32x16_bf16 a[96:111], v[100:103], a[196:199], a[96:111]
    ds_write_b128 v6, a[72:75] offset:20480
    v_mfma_f32_32x32x16_bf16 a[112:127], v[100:103], a[212:215], a[112:127]
    s_waitcnt vmcnt(13)
    v_mfma_f32_32x32x16_bf16 a[96:111], v[104:107], a[200:203], a[96:111]
    ds_write_b128 v6, a[76:79] offset:21504
    v_mfma_f32_32x32x16_bf16 a[112:127], v[104:107], a[216:219], a[112:127]
    s_waitcnt vmcnt(12)
    v_mfma_f32_32x32x16_bf16 a[96:111], v[108:111], a[204:207], a[96:111]
    s_waitcnt lgkmcnt(2)
    v_add_f32 v176, v176, v184
    v_add_f32 v177, v177, v185
    v_add_f32 v178, v178, v186
    v_add_f32 v179, v179, v187
    v_mfma_f32_32x32x16_bf16 a[112:127], v[108:111], a[220:223], a[112:127]
    v_add_f32 v180, v180, v188
    ds_write_b128 v6, a[80:83] offset:18432
    v_add_f32 v181, v181, v189
    s_waitcnt vmcnt(11)
    v_mfma_f32_32x32x16_bf16 a[96:111], v[112:115], a[224:227], a[96:111]
    v_add_f32 v182, v182, v190
    v_add_f32 v183, v183, v191
    v_add_f32 v176, v176, v192
    v_add_f32 v177, v177, v193
    v_add_f32 v178, v178, v194
    v_mfma_f32_32x32x16_bf16 a[112:127], v[112:115], a[0:3], a[112:127]
    v_add_f32 v179, v179, v195
    v_add_f32 v180, v180, v196
    v_add_f32 v181, v181, v197
    s_waitcnt vmcnt(8)
    v_mfma_f32_32x32x16_bf16 a[96:111], v[116:119], a[228:231], a[96:111]
    ds_write_b128 v6, a[84:87] offset:19456
    v_add_f32 v182, v182, v198
    v_mfma_f32_32x32x16_bf16 a[112:127], v[116:119], a[4:7], a[112:127]
    v_add_f32 v183, v183, v199
    v_add_f32 v176, v176, v200
    v_add_f32 v177, v177, v201
    v_add_f32 v178, v178, v202
    v_add_f32 v179, v179, v203
    v_add_f32 v180, v180, v204
    s_waitcnt vmcnt(7)
    v_mfma_f32_32x32x16_bf16 a[96:111], v[120:123], a[232:235], a[96:111]
    v_add_f32 v181, v181, v205
    v_add_f32 v182, v182, v206
    v_mfma_f32_32x32x16_bf16 a[112:127], v[120:123], a[8:11], a[112:127]
    ds_write_b128 v6, a[88:91] offset:22528
    v_add_f32 v183, v183, v207
    v_mul_f32 v176, v176, v208
    s_waitcnt vmcnt(6)
    v_mfma_f32_32x32x16_bf16 a[96:111], v[124:127], a[236:239], a[96:111]
    v_mul_f32 v177, v177, v209
    v_mul_f32 v178, v178, v210
    v_mul_f32 v179, v179, v211
    v_mul_f32 v180, v180, v212
    v_mul_f32 v181, v181, v213
    v_mfma_f32_32x32x16_bf16 a[112:127], v[124:127], a[12:15], a[112:127]
    v_mul_f32 v182, v182, v214
    s_waitcnt vmcnt(4)
    v_mov_b32 v14, s53
    buffer_store_dword v14, v61, s[20:23], s62 offen sc1
    v_mul_f32 v183, v183, v215
    ds_write_b128 v6, a[92:95] offset:23552
    v_cvt_pk_bf16_f32 v208, v176, v177
    v_cvt_pk_bf16_f32 v209, v178, v179
    v_cvt_pk_bf16_f32 v210, v180, v181
    v_cvt_pk_bf16_f32 v211, v182, v183
    buffer_store_dwordx4 v[208:211], v0, s[20:23], s70 offen sc1
LJ_10:
    s_waitcnt lgkmcnt(0)
    s_barrier
    ds_read_b128 v[72:75], v7 offset:18432
    ds_read_b128 v[76:79], v7 offset:19456
    ds_read_b128 v[80:83], v8 offset:20480
    ds_read_b128 v[84:87], v8 offset:21504
    ds_read_b128 v[88:91], v9 offset:22528
    ds_read_b128 v[92:95], v9 offset:23552
    v_accvgpr_read_b32 v64, a64
    v_accvgpr_read_b32 v65, a65
    v_accvgpr_read_b32 v66, a66
    ds_write_b128 v6, a[104:107] offset:14336
    v_accvgpr_read_b32 v67, a67
    v_accvgpr_read_b32 v68, a68
    v_accvgpr_read_b32 v69, a69
    ds_write_b128 v6, a[108:111] offset:15360
    v_accvgpr_read_b32 v70, a70
    v_accvgpr_read_b32 v71, a71
    v_lshlrev_b32 v96, 16, v48
    ds_write_b128 v6, a[112:115] offset:12288
    v_and_b32 v97, 0xffff0000, v48
    v_lshlrev_b32 v98, 16, v49
    v_and_b32 v99, 0xffff0000, v49
    ds_write_b128 v6, a[116:119] offset:13312
    v_lshlrev_b32 v100, 16, v50
    v_and_b32 v101, 0xffff0000, v50
    v_lshlrev_b32 v102, 16, v51
    ds_write_b128 v6, a[120:123] offset:16384
    v_and_b32 v103, 0xffff0000, v51
    v_pk_add_f32 v[64:65], v[64:65], v[32:33] op_sel_hi:[1,0]
    v_pk_add_f32 v[66:67], v[66:67], v[32:33] op_sel_hi:[1,0]
    ds_write_b128 v6, a[124:127] offset:17408
    v_pk_add_f32 v[68:69], v[68:69], v[32:33] op_sel_hi:[1,0]
    v_pk_add_f32 v[70:71], v[70:71], v[32:33] op_sel_hi:[1,0]
    s_add_u32 s71, s84, 2
    s_add_u32 s70, s58, 7342080
    s_cmp_le_u32 s71, 42
    s_cselect_b32 s70, s70, 1073741824
    s_waitcnt lgkmcnt(6)
    v_pk_add_f32 v[72:73], v[72:73], v[80:81]
    v_pk_add_f32 v[64:65], v[64:65], v[88:89]
    v_pk_add_f32 v[74:75], v[74:75], v[82:83]
    v_pk_add_f32 v[66:67], v[66:67], v[90:91]
    s_add_u32 m0, s54, 0
    s_add_u32 s74, s15, 0
    buffer_load_dwordx4 v16, s[28:31], s74 offen offset:0 lds
    v_pk_add_f32 v[76:77], v[76:77], v[84:85]
    v_pk_add_f32 v[68:69], v[68:69], v[92:93]
    v_pk_add_f32 v[78:79], v[78:79], v[86:87]
    v_pk_add_f32 v[70:71], v[70:71], v[94:95]
    buffer_load_dwordx4 v17, s[28:31], s74 offen offset:1024 lds
    v_pk_add_f32 v[64:65], v[64:65], v[72:73]
    v_pk_add_f32 v[66:67], v[66:67], v[74:75]
    v_pk_add_f32 v[68:69], v[68:69], v[76:77]
    v_pk_add_f32 v[70:71], v[70:71], v[78:79]
    buffer_load_dwordx4 v18, s[28:31], s74 offen offset:2048 lds
    v_pk_mul_f32 v[64:65], v[64:65], v[96:97]
    v_pk_mul_f32 v[66:67], v[66:67], v[98:99]
    v_pk_mul_f32 v[68:69], v[68:69], v[100:101]
    v_pk_mul_f32 v[70:71], v[70:71], v[102:103]
    buffer_load_dwordx4 v19, s[28:31], s74 offen offset:3072 lds
    v_cvt_pk_bf16_f32 v96, v64, v65
    v_cvt_pk_bf16_f32 v97, v66, v67
    v_cvt_pk_bf16_f32 v98, v68, v69
    v_cvt_pk_bf16_f32 v99, v70, v71
    buffer_store_dwordx4 v[96:99], v0, s[20:23], s70 offen sc1
    v_accvgpr_read_b32 v104, a96
    v_accvgpr_read_b32 v105, a97
    v_accvgpr_read_b32 v106, a98
    v_accvgpr_read_b32 v107, a99
    s_add_u32 m0, s54, 4096
    s_add_u32 s74, s15, 32768
    buffer_load_dwordx4 v16, s[28:31], s74 offen offset:0 lds
    v_accvgpr_read_b32 v108, a100
    v_accvgpr_read_b32 v109, a101
    v_accvgpr_read_b32 v110, a102
    v_accvgpr_read_b32 v111, a103
    buffer_load_dwordx4 v17, s[28:31], s74 offen offset:1024 lds
    v_lshlrev_b32 v136, 16, v52
    v_and_b32 v137, 0xffff0000, v52
    v_lshlrev_b32 v138, 16, v53
    v_and_b32 v139, 0xffff0000, v53
    buffer_load_dwordx4 v18, s[28:31], s74 offen offset:2048 lds
    v_lshlrev_b32 v140, 16, v54
    v_and_b32 v141, 0xffff0000, v54
    v_lshlrev_b32 v142, 16, v55
    v_and_b32 v143, 0xffff0000, v55
    buffer_load_dwordx4 v19, s[28:31], s74 offen offset:3072 lds
    v_pk_add_f32 v[104:105], v[104:105], v[32:33] op_sel_hi:[1,0]
    v_pk_add_f32 v[106:107], v[106:107], v[32:33] op_sel_hi:[1,0]
    v_pk_add_f32 v[108:109], v[108:109], v[32:33] op_sel_hi:[1,0]
    v_pk_add_f32 v[110:111], v[110:111], v[32:33] op_sel_hi:[1,0]
    s_add_u32 s71, s84, 4
    s_add_u32 s70, s58, 7344128
    s_cmp_le_u32 s71, 42
    s_cselect_b32 s70, s70, 1073741824
    buffer_load_dword v27, v41, s[20:23], s5 offen sc1
    s_waitcnt lgkmcnt(0)
    s_barrier
    ds_read_b128 v[112:115], v7 offset:12288
    ds_read_b128 v[116:119], v7 offset:13312
    ds_read_b128 v[120:123], v8 offset:14336
    ds_read_b128 v[124:127], v8 offset:15360
    ds_read_b128 v[128:131], v9 offset:16384
    ds_read_b128 v[132:135], v9 offset:17408
    s_add_u32 m0, s54, 24576
    s_add_u32 s74, s15, 131072
    buffer_load_dwordx4 v16, s[28:31], s74 offen offset:0 lds
    buffer_load_dwordx4 v17, s[28:31], s74 offen offset:1024 lds
    buffer_load_dwordx4 v18, s[28:31], s74 offen offset:2048 lds
    buffer_load_dwordx4 v19, s[28:31], s74 offen offset:3072 lds
    s_waitcnt lgkmcnt(0)
    v_pk_add_f32 v[112:113], v[112:113], v[120:121]
    v_pk_add_f32 v[104:105], v[104:105], v[128:129]
    v_pk_add_f32 v[114:115], v[114:115], v[122:123]
    v_pk_add_f32 v[106:107], v[106:107], v[130:131]
    s_add_u32 m0, s54, 28672
    s_add_u32 s74, s15, 163840
    buffer_load_dwordx4 v16, s[28:31], s74 offen offset:0 lds
    v_pk_add_f32 v[116:117], v[116:117], v[124:125]
    v_pk_add_f32 v[108:109], v[108:109], v[132:133]
    v_pk_add_f32 v[118:119], v[118:119], v[126:127]
    v_pk_add_f32 v[110:111], v[110:111], v[134:135]
    buffer_load_dwordx4 v17, s[28:31], s74 offen offset:1024 lds
    v_pk_add_f32 v[104:105], v[104:105], v[112:113]
    v_pk_add_f32 v[106:107], v[106:107], v[114:115]
    v_pk_add_f32 v[108:109], v[108:109], v[116:117]
    v_pk_add_f32 v[110:111], v[110:111], v[118:119]
    buffer_load_dwordx4 v18, s[28:31], s74 offen offset:2048 lds
    v_pk_mul_f32 v[104:105], v[104:105], v[136:137]
    v_pk_mul_f32 v[106:107], v[106:107], v[138:139]
    v_pk_mul_f32 v[108:109], v[108:109], v[140:141]
    v_pk_mul_f32 v[110:111], v[110:111], v[142:143]
    buffer_load_dwordx4 v19, s[28:31], s74 offen offset:3072 lds
    v_cvt_pk_bf16_f32 v136, v104, v105
    v_cvt_pk_bf16_f32 v137, v106, v107
    v_cvt_pk_bf16_f32 v138, v108, v109
    v_cvt_pk_bf16_f32 v139, v110, v111
    buffer_store_dwordx4 v[136:139], v0, s[20:23], s70 offen sc1
    s_waitcnt vmcnt(9)
    v_cmp_ne_u32 vcc, s53, v27
    s_nop 1
    s_and_b32 s68, vcc_lo, 15
    s_cbranch_scc1 Los_51
Lob_52:
    buffer_load_dwordx4 a[128:131], v0, s[20:23], s7 offen offset:0 sc1
    buffer_load_dwordx4 a[132:135], v0, s[20:23], s7 offen offset:1024 sc1
    buffer_load_dwordx4 a[136:139], v0, s[20:23], s7 offen offset:2048 sc1
    buffer_load_dwordx4 a[140:143], v0, s[20:23], s7 offen offset:3072 sc1
    s_add_u32 s7, s7, 4096
    buffer_load_dwordx4 a[144:147], v0, s[20:23], s7 offen offset:0 sc1
    buffer_load_dwordx4 a[148:151], v0, s[20:23], s7 offen offset:1024 sc1
    buffer_load_dwordx4 a[152:155], v0, s[20:23], s7 offen offset:2048 sc1
    buffer_load_dwordx4 a[156:159], v0, s[20:23], s7 offen offset:3072 sc1
    s_add_u32 s7, s7, 4096
    buffer_load_dwordx4 a[160:163], v0, s[20:23], s7 offen offset:0 sc1
    buffer_load_dwordx4 a[164:167], v0, s[20:23], s7 offen offset:1024 sc1
    s_waitcnt vmcnt(11)
    s_barrier
    s_waitcnt vmcnt(10)
    v_mov_b32 v14, s53
    buffer_store_dword v14, v61, s[20:23], s6 offen sc1
    ds_read_b64_tr_b16 v[160:161], v36 offset:0
    ds_read_b64_tr_b16 v[162:163], v36 offset:512
    ds_read_b64_tr_b16 v[164:165], v37 offset:0
    ds_read_b64_tr_b16 v[166:167], v37 offset:512
    ds_read_b64_tr_b16 v[168:169], v36 offset:1024
    ds_read_b64_tr_b16 v[170:171], v36 offset:1536
    ds_read_b64_tr_b16 v[172:173], v37 offset:1024
    ds_read_b64_tr_b16 v[174:175], v37 offset:1536
    ds_read_b64_tr_b16 v[176:177], v36 offset:4096
    ds_read_b64_tr_b16 v[178:179], v36 offset:4608
    ds_read_b64_tr_b16 v[180:181], v37 offset:4096
    ds_read_b64_tr_b16 v[182:183], v37 offset:4608
    s_waitcnt vmcnt(10) lgkmcnt(8)
    v_mfma_f32_32x32x16_bf16 v[192:207], v[160:163], a[128:131], 0
    ds_read_b64_tr_b16 v[184:185], v36 offset:5120
    ds_read_b64_tr_b16 v[186:187], v36 offset:5632
    v_mfma_f32_32x32x16_bf16 v[208:223], v[164:167], a[128:131], 0
    ds_read_b64_tr_b16 v[188:189], v37 offset:5120
    ds_read_b64_tr_b16 v[190:191], v37 offset:5632
    buffer_load_dwordx4 a[168:171], v0, s[20:23], s7 offen offset:2048 sc1
    s_waitcnt vmcnt(10) lgkmcnt(8)
    v_mfma_f32_32x32x16_bf16 v[192:207], v[168:171], a[132:135], v[192:207]
    ds_read_b64_tr_b16 v[160:161], v36 offset:32768
    ds_read_b64_tr_b16 v[162:163], v36 offset:33280
    buffer_load_dwordx4 a[172:175], v0, s[20:23], s7 offen offset:3072 sc1
    v_mfma_f32_32x32x16_bf16 v[208:223], v[172:175], a[132:135], v[208:223]
    ds_read_b64_tr_b16 v[164:165], v37 offset:32768
    ds_read_b64_tr_b16 v[166:167], v37 offset:33280
    s_add_u32 s7, s7, 4096
    buffer_load_dwordx4 a[176:179], v0, s[20:23], s7 offen offset:0 sc1
    s_waitcnt vmcnt(11) lgkmcnt(8)
    v_mfma_f32_32x32x16_bf16 v[192:207], v[176:179], a[136:139], v[192:207]
    ds_read_b64_tr_b16 v[168:169], v36 offset:33792
    ds_read_b64_tr_b16 v[170:171], v36 offset:34304
    buffer_load_dwordx4 a[180:183], v0, s[20:23], s7 offen offset:1024 sc1
    v_mfma_f32_32x32x16_bf16 v[208:223], v[180:183], a[136:139], v[208:223]
    ds_read_b64_tr_b16 v[172:173], v37 offset:33792
    ds_read_b64_tr_b16 v[174:175], v37 offset:34304
    buffer_load_dwordx4 a[184:187], v0, s[20:23], s7 offen offset:2048 sc1
    s_waitcnt vmcnt(12) lgkmcnt(8)
    v_mfma_f32_32x32x16_bf16 v[192:207], v[184:187], a[140:143], v[192:207]
    ds_read_b64_tr_b16 v[176:177], v36 offset:36864
    ds_read_b64_tr_b16 v[178:179], v36 offset:37376
    buffer_load_dwordx4 a[188:191], v0, s[20:23], s7 offen offset:3072 sc1
    v_mfma_f32_32x32x16_bf16 v[208:223], v[188:191], a[140:143], v[208:223]
    ds_read_b64_tr_b16 v[180:181], v37 offset:36864
    ds_read_b64_tr_b16 v[182:183], v37 offset:37376
    s_add_u32 m0, s79, 135168
    s_add_u32 s74, s4, 294912
    s_waitcnt vmcnt(12) lgkmcnt(8)
    v_mfma_f32_32x32x16_bf16 v[192:207], v[160:163], a[144:147], v[192:207]
    ds_read_b64_tr_b16 v[184:185], v36 offset:37888
    ds_read_b64_tr_b16 v[186:187], v36 offset:38400
    buffer_load_dwordx4 v16, s[32:35], s74 offen offset:0 lds
    v_mfma_f32_32x32x16_bf16 v[208:223], v[164:167], a[144:147], v[208:223]
    ds_read_b64_tr_b16 v[188:189], v37 offset:37888
    ds_read_b64_tr_b16 v[190:191], v37 offset:38400
    buffer_load_dwordx4 v17, s[32:35], s74 offen offset:1024 lds
    s_waitcnt vmcnt(13) lgkmcnt(8)
    v_mfma_f32_32x32x16_bf16 v[192:207], v[168:171], a[148:151], v[192:207]
    ds_read_b64_tr_b16 v[160:161], v36 offset:24576
    ds_read_b64_tr_b16 v[162:163], v36 offset:25088
    buffer_load_dwordx4 v18, s[32:35], s74 offen offset:2048 lds
    v_mfma_f32_32x32x16_bf16 v[208:223], v[172:175], a[148:151], v[208:223]
    ds_read_b64_tr_b16 v[164:165], v37 offset:24576
    ds_read_b64_tr_b16 v[166:167], v37 offset:25088
    buffer_load_dwordx4 v19, s[32:35], s74 offen offset:3072 lds
    s_add_u32 m0, s54, 8192
    s_add_u32 s74, s75, 0
    s_waitcnt vmcnt(14) lgkmcnt(8)
    v_mfma_f32_32x32x16_bf16 v[192:207], v[176:179], a[152:155], v[192:207]
    ds_read_b64_tr_b16 v[168:169], v36 offset:25600
    ds_read_b64_tr_b16 v[170:171], v36 offset:26112
    buffer_load_dwordx4 v16, s[32:35], s74 offen offset:0 lds
    v_mfma_f32_32x32x16_bf16 v[208:223], v[180:183], a[152:155], v[208:223]
    ds_read_b64_tr_b16 v[172:173], v37 offset:25600
    ds_read_b64_tr_b16 v[174:175], v37 offset:26112
    buffer_load_dwordx4 v17, s[32:35], s74 offen offset:1024 lds
    s_waitcnt vmcnt(15) lgkmcnt(8)
    v_mfma_f32_32x32x16_bf16 v[192:207], v[184:187], a[156:159], v[192:207]
    ds_read_b64_tr_b16 v[176:177], v36 offset:28672
    ds_read_b64_tr_b16 v[178:179], v36 offset:29184
    v_mfma_f32_32x32x16_bf16 v[208:223], v[188:191], a[156:159], v[208:223]
    ds_read_b64_tr_b16 v[180:181], v37 offset:28672
    ds_read_b64_tr_b16 v[182:183], v37 offset:29184
    buffer_load_dwordx4 v18, s[32:35], s74 offen offset:2048 lds
    s_waitcnt vmcnt(15) lgkmcnt(8)
    v_mfma_f32_32x32x16_bf16 v[192:207], v[160:163], a[160:163], v[192:207]
    ds_read_b64_tr_b16 v[184:185], v36 offset:29696
    ds_read_b64_tr_b16 v[186:187], v36 offset:30208
    buffer_load_dwordx4 v19, s[32:35], s74 offen offset:3072 lds
    s_add_u32 m0, s54, 12288
    s_add_u32 s74, s75, 32768
    v_mfma_f32_32x32x16_bf16 v[208:223], v[164:167], a[160:163], v[208:223]
    ds_read_b64_tr_b16 v[188:189], v37 offset:29696
    ds_read_b64_tr_b16 v[190:191], v37 offset:30208
    buffer_load_dwordx4 v16, s[32:35], s74 offen offset:0 lds
    s_waitcnt vmcnt(16) lgkmcnt(8)
    v_mfma_f32_32x32x16_bf16 v[192:207], v[168:171], a[164:167], v[192:207]
    ds_read_b64_tr_b16 v[160:161], v36 offset:57344
    ds_read_b64_tr_b16 v[162:163], v36 offset:57856
    buffer_load_dwordx4 v17, s[32:35], s74 offen offset:1024 lds
    v_mfma_f32_32x32x16_bf16 v[208:223], v[172:175], a[164:167], v[208:223]
    ds_read_b64_tr_b16 v[164:165], v37 offset:57344
    ds_read_b64_tr_b16 v[166:167], v37 offset:57856
    buffer_load_dwordx4 v18, s[32:35], s74 offen offset:2048 lds
    s_waitcnt vmcnt(16) lgkmcnt(8)
    v_mfma_f32_32x32x16_bf16 v[192:207], v[176:179], a[168:171], v[192:207]
    ds_read_b64_tr_b16 v[168:169], v36 offset:58368
    ds_read_b64_tr_b16 v[170:171], v36 offset:58880
    v_mfma_f32_32x32x16_bf16 v[208:223], v[180:183], a[168:171], v[208:223]
    ds_read_b64_tr_b16 v[172:173], v37 offset:58368
    ds_read_b64_tr_b16 v[174:175], v37 offset:58880
    buffer_load_dwordx4 v19, s[32:35], s74 offen offset:3072 lds
    s_add_u32 m0, s54, 16384
    s_add_u32 s74, s75, 65536
    s_waitcnt vmcnt(16) lgkmcnt(8)
    v_mfma_f32_32x32x16_bf16 v[192:207], v[184:187], a[172:175], v[192:207]
    ds_read_b64_tr_b16 v[176:177], v36 offset:61440
    ds_read_b64_tr_b16 v[178:179], v36 offset:61952
    buffer_load_dwordx4 v16, s[32:35], s74 offen offset:0 lds
    v_mfma_f32_32x32x16_bf16 v[208:223], v[188:191], a[172:175], v[208:223]
    ds_read_b64_tr_b16 v[180:181], v37 offset:61440
    ds_read_b64_tr_b16 v[182:183], v37 offset:61952
    buffer_load_dwordx4 v17, s[32:35], s74 offen offset:1024 lds
    s_waitcnt vmcnt(17) lgkmcnt(8)
    v_mfma_f32_32x32x16_bf16 v[192:207], v[160:163], a[176:179], v[192:207]
    ds_read_b64_tr_b16 v[184:185], v36 offset:62464
    ds_read_b64_tr_b16 v[186:187], v36 offset:62976
    buffer_load_dwordx4 v18, s[32:35], s74 offen offset:2048 lds
    v_mfma_f32_32x32x16_bf16 v[208:223], v[164:167], a[176:179], v[208:223]
    ds_read_b64_tr_b16 v[188:189], v37 offset:62464
    ds_read_b64_tr_b16 v[190:191], v37 offset:62976
    buffer_load_dwordx4 v19, s[32:35], s74 offen offset:3072 lds
    s_waitcnt vmcnt(18) lgkmcnt(8)
    v_mfma_f32_32x32x16_bf16 v[192:207], v[168:171], a[180:183], v[192:207]
    s_add_u32 m0, s54, 20480
    s_add_u32 s74, s75, 98304
    v_mfma_f32_32x32x16_bf16 v[208:223], v[172:175], a[180:183], v[208:223]
    buffer_load_dwordx4 v16, s[32:35], s74 offen offset:0 lds
    s_waitcnt vmcnt(18) lgkmcnt(4)
    v_mfma_f32_32x32x16_bf16 v[192:207], v[176:179], a[184:187], v[192:207]
    buffer_load_dwordx4 v17, s[32:35], s74 offen offset:1024 lds
    v_mfma_f32_32x32x16_bf16 v[208:223], v[180:183], a[184:187], v[208:223]
    buffer_load_dwordx4 v18, s[32:35], s74 offen offset:2048 lds
    s_waitcnt vmcnt(19) lgkmcnt(0)
    v_mfma_f32_32x32x16_bf16 v[192:207], v[184:187], a[188:191], v[192:207]
    buffer_load_dwordx4 v19, s[32:35], s74 offen offset:3072 lds
    v_mfma_f32_32x32x16_bf16 v[208:223], v[188:191], a[188:191], v[208:223]
    buffer_load_dword v27, v40, s[20:23], s82 offen sc1
    v_add_u32 v2, s54, v0
    v_xor_b32 v3, 0x10000, v2
    s_cmp_eq_u32 s12, 1
    s_cselect_b32 s72, 1073741824, s41
    s_waitcnt vmcnt(0)
    v_cmp_ne_u32 vcc, s53, v27
    s_nop 1
    s_and_b32 s68, vcc_lo, 65535
    s_cbranch_scc1 Ls_53
Lb_54:
    s_add_u32 s71, s41, 0
    buffer_load_dwordx4 v[64:67], v0, s[20:23], s71 offen sc1
    s_add_u32 s71, s41, 1024
    buffer_load_dwordx4 v[68:71], v0, s[20:23], s71 offen sc1
    s_add_u32 s71, s41, 2048
    buffer_load_dwordx4 v[72:75], v0, s[20:23], s71 offen sc1
    s_add_u32 s71, s41, 3072
    buffer_load_dwordx4 v[76:79], v0, s[20:23], s71 offen sc1
    s_barrier
    ds_write_b128 v2, v[208:211] offset:0
    s_add_u32 s71, s41, 4096
    buffer_load_dwordx4 v[80:83], v0, s[20:23], s71 offen sc1
    ds_write_b128 v2, v[212:215] offset:1024
    s_add_u32 s71, s41, 5120
    buffer_load_dwordx4 v[84:87], v0, s[20:23], s71 offen sc1
    ds_write_b128 v2, v[216:219] offset:2048
    s_add_u32 s71, s41, 6144
    buffer_load_dwordx4 v[88:91], v0, s[20:23], s71 offen sc1
    ds_write_b128 v2, v[220:223] offset:3072
    s_add_u32 s71, s41, 7168
    buffer_load_dwordx4 v[92:95], v0, s[20:23], s71 offen sc1
    s_or_b32 s68, s2, s48
    s_cmp_eq_u32 s68, 0
    s_cbranch_scc0 Lg_55
    s_mov_b32 s69, 12976128
    v_lshlrev_b32 v5, 11, v1
    buffer_load_dword v8, v5, s[20:23], s69 offen offset:0 sc1
    buffer_load_dword v9, v5, s[20:23], s69 offen offset:512 sc1
    buffer_load_dword v10, v5, s[20:23], s69 offen offset:1024 sc1
    buffer_load_dword v11, v5, s[20:23], s69 offen offset:1536 sc1
Lg_55:
    ds_read_b64_tr_b16 v[160:161], v28 offset:8192
    ds_read_b64_tr_b16 v[162:163], v28 offset:9216
    ds_read_b64_tr_b16 v[164:165], v29 offset:8192
    ds_read_b64_tr_b16 v[166:167], v29 offset:9216
    ds_read_b64_tr_b16 v[168:169], v28 offset:10240
    ds_read_b64_tr_b16 v[170:171], v28 offset:11264
    ds_read_b64_tr_b16 v[172:173], v29 offset:10240
    ds_read_b64_tr_b16 v[174:175], v29 offset:11264
    ds_read_b64_tr_b16 v[176:177], v28 offset:12288
    ds_read_b64_tr_b16 v[178:179], v28 offset:13312
    ds_read_b64_tr_b16 v[180:181], v29 offset:12288
    ds_read_b64_tr_b16 v[182:183], v29 offset:13312
    s_waitcnt vmcnt(7) lgkmcnt(8)
    v_mfma_f32_32x32x16_bf16 v[224:239], v[160:163], v[64:67], 0
    ds_read_b64_tr_b16 v[184:185], v28 offset:14336
    ds_read_b64_tr_b16 v[186:187], v28 offset:15360
    v_mfma_f32_32x32x16_bf16 v[240:255], v[164:167], v[64:67], 0
    ds_read_b64_tr_b16 v[188:189], v29 offset:14336
    ds_read_b64_tr_b16 v[190:191], v29 offset:15360
    s_waitcnt vmcnt(6) lgkmcnt(8)
    v_mfma_f32_32x32x16_bf16 v[224:239], v[168:171], v[68:71], v[224:239]
    ds_read_b64_tr_b16 v[160:161], v28 offset:16384
    ds_read_b64_tr_b16 v[162:163], v28 offset:17408
    s_add_u32 s71, s41, 8192
    buffer_load_dwordx4 v[96:99], v0, s[20:23], s71 offen sc1
    v_mfma_f32_32x32x16_bf16 v[240:255], v[172:175], v[68:71], v[240:255]
    ds_read_b64_tr_b16 v[164:165], v29 offset:16384
    ds_read_b64_tr_b16 v[166:167], v29 offset:17408
    s_waitcnt vmcnt(6) lgkmcnt(8)
    v_mfma_f32_32x32x16_bf16 v[224:239], v[176:179], v[72:75], v[224:239]
    ds_read_b64_tr_b16 v[168:169], v28 offset:18432
    ds_read_b64_tr_b16 v[170:171], v28 offset:19456
    s_add_u32 s71, s41, 9216
    buffer_load_dwordx4 v[100:103], v0, s[20:23], s71 offen sc1
    v_mfma_f32_32x32x16_bf16 v[240:255], v[180:183], v[72:75], v[240:255]
    ds_read_b64_tr_b16 v[172:173], v29 offset:18432
    ds_read_b64_tr_b16 v[174:175], v29 offset:19456
    s_waitcnt vmcnt(6) lgkmcnt(8)
    v_mfma_f32_32x32x16_bf16 v[224:239], v[184:187], v[76:79], v[224:239]
    ds_read_b64_tr_b16 v[176:177], v28 offset:20480
    ds_read_b64_tr_b16 v[178:179], v28 offset:21504
    s_add_u32 s71, s41, 10240
    buffer_load_dwordx4 v[104:107], v0, s[20:23], s71 offen sc1
    v_mfma_f32_32x32x16_bf16 v[240:255], v[188:191], v[76:79], v[240:255]
    ds_read_b64_tr_b16 v[180:181], v29 offset:20480
    ds_read_b64_tr_b16 v[182:183], v29 offset:21504
    s_waitcnt vmcnt(6) lgkmcnt(8)
    v_mfma_f32_32x32x16_bf16 v[224:239], v[160:163], v[80:83], v[224:239]
    ds_read_b64_tr_b16 v[184:185], v28 offset:22528
    ds_read_b64_tr_b16 v[186:187], v28 offset:23552
    s_add_u32 s71, s41, 11264
    buffer_load_dwordx4 v[108:111], v0, s[20:23], s71 offen sc1
    v_mfma_f32_32x32x16_bf16 v[240:255], v[164:167], v[80:83], v[240:255]
    ds_read_b64_tr_b16 v[188:189], v29 offset:22528
    ds_read_b64_tr_b16 v[190:191], v29 offset:23552
    s_waitcnt vmcnt(6) lgkmcnt(8)
    v_mfma_f32_32x32x16_bf16 v[224:239], v[168:171], v[84:87], v[224:239]
    ds_read_b64_tr_b16 v[160:161], v28 offset:40960
    ds_read_b64_tr_b16 v[162:163], v28 offset:41984
    s_add_u32 s71, s41, 12288
    buffer_load_dwordx4 v[112:115], v0, s[20:23], s71 offen sc1
    v_mfma_f32_32x32x16_bf16 v[240:255], v[172:175], v[84:87], v[240:255]
    ds_read_b64_tr_b16 v[164:165], v29 offset:40960
    ds_read_b64_tr_b16 v[166:167], v29 offset:41984
    s_waitcnt vmcnt(6) lgkmcnt(8)
    v_mfma_f32_32x32x16_bf16 v[224:239], v[176:179], v[88:91], v[224:239]
    ds_read_b64_tr_b16 v[168:169], v28 offset:43008
    ds_read_b64_tr_b16 v[170:171], v28 offset:44032
    s_add_u32 s71, s41, 13312
    buffer_load_dwordx4 v[116:119], v0, s[20:23], s71 offen sc1
    v_mfma_f32_32x32x16_bf16 v[240:255], v[180:183], v[88:91], v[240:255]
    ds_read_b64_tr_b16 v[172:173], v29 offset:43008
    ds_read_b64_tr_b16 v[174:175], v29 offset:44032
    s_waitcnt vmcnt(6) lgkmcnt(8)
    v_mfma_f32_32x32x16_bf16 v[224:239], v[184:187], v[92:95], v[224:239]
    ds_read_b64_tr_b16 v[176:177], v28 offset:45056
    ds_read_b64_tr_b16 v[178:179], v28 offset:46080
    s_add_u32 s71, s41, 14336
    buffer_load_dwordx4 v[120:123], v0, s[20:23], s71 offen sc1
    v_mfma_f32_32x32x16_bf16 v[240:255], v[188:191], v[92:95], v[240:255]
    ds_read_b64_tr_b16 v[180:181], v29 offset:45056
    ds_read_b64_tr_b16 v[182:183], v29 offset:46080
    s_waitcnt vmcnt(6) lgkmcnt(8)
    v_mfma_f32_32x32x16_bf16 v[224:239], v[160:163], v[96:99], v[224:239]
    ds_read_b64_tr_b16 v[184:185], v28 offset:47104
    ds_read_b64_tr_b16 v[186:187], v28 offset:48128
    s_add_u32 s71, s41, 15360
    buffer_load_dwordx4 v[124:127], v0, s[20:23], s71 offen sc1
    v_mfma_f32_32x32x16_bf16 v[240:255], v[164:167], v[96:99], v[240:255]
    ds_read_b64_tr_b16 v[188:189], v29 offset:47104
    ds_read_b64_tr_b16 v[190:191], v29 offset:48128
    s_waitcnt vmcnt(6) lgkmcnt(8)
    v_mfma_f32_32x32x16_bf16 v[224:239], v[168:171], v[100:103], v[224:239]
    ds_read_b64_tr_b16 v[160:161], v28 offset:49152
    ds_read_b64_tr_b16 v[162:163], v28 offset:50176
    s_add_u32 s71, s41, 16384
    buffer_load_dwordx4 v[128:131], v0, s[20:23], s71 offen sc1
    v_mfma_f32_32x32x16_bf16 v[240:255], v[172:175], v[100:103], v[240:255]
    ds_read_b64_tr_b16 v[164:165], v29 offset:49152
    ds_read_b64_tr_b16 v[166:167], v29 offset:50176
    s_waitcnt vmcnt(6) lgkmcnt(8)
    v_mfma_f32_32x32x16_bf16 v[224:239], v[176:179], v[104:107], v[224:239]
    ds_read_b64_tr_b16 v[168:169], v28 offset:51200
    ds_read_b64_tr_b16 v[170:171], v28 offset:52224
    s_add_u32 s71, s41, 17408
    buffer_load_dwordx4 v[132:135], v0, s[20:23], s71 offen sc1
    v_mfma_f32_32x32x16_bf16 v[240:255], v[180:183], v[104:107], v[240:255]
    ds_read_b64_tr_b16 v[172:173], v29 offset:51200
    ds_read_b64_tr_b16 v[174:175], v29 offset:52224
    s_waitcnt vmcnt(6) lgkmcnt(8)
    v_mfma_f32_32x32x16_bf16 v[224:239], v[184:187], v[108:111], v[224:239]
    ds_read_b64_tr_b16 v[176:177], v28 offset:53248
    ds_read_b64_tr_b16 v[178:179], v28 offset:54272
    s_add_u32 s71, s41, 18432
    buffer_load_dwordx4 v[136:139], v0, s[20:23], s71 offen sc1
    v_mfma_f32_32x32x16_bf16 v[240:255], v[188:191], v[108:111], v[240:255]
    ds_read_b64_tr_b16 v[180:181], v29 offset:53248
    ds_read_b64_tr_b16 v[182:183], v29 offset:54272
    s_waitcnt vmcnt(6) lgkmcnt(8)
    v_mfma_f32_32x32x16_bf16 v[224:239], v[160:163], v[112:115], v[224:239]
    ds_read_b64_tr_b16 v[184:185], v28 offset:55296
    ds_read_b64_tr_b16 v[186:187], v28 offset:56320
    s_add_u32 s71, s41, 19456
    buffer_load_dwordx4 v[140:143], v0, s[20:23], s71 offen sc1
    v_mfma_f32_32x32x16_bf16 v[240:255], v[164:167], v[112:115], v[240:255]
    ds_read_b64_tr_b16 v[188:189], v29 offset:55296
    ds_read_b64_tr_b16 v[190:191], v29 offset:56320
    s_waitcnt vmcnt(6) lgkmcnt(8)
    v_mfma_f32_32x32x16_bf16 v[224:239], v[168:171], v[116:119], v[224:239]
    ds_read_b64_tr_b16 v[160:161], v38 offset:0
    ds_read_b64_tr_b16 v[162:163], v38 offset:1024
    s_add_u32 s71, s41, 20480
    buffer_load_dwordx4 v[144:147], v0, s[20:23], s71 offen sc1
    v_mfma_f32_32x32x16_bf16 v[240:255], v[172:175], v[116:119], v[240:255]
    ds_read_b64_tr_b16 v[164:165], v39 offset:0
    ds_read_b64_tr_b16 v[166:167], v39 offset:1024
    s_waitcnt vmcnt(6) lgkmcnt(8)
    v_mfma_f32_32x32x16_bf16 v[224:239], v[176:179], v[120:123], v[224:239]
    ds_read_b64_tr_b16 v[168:169], v38 offset:2048
    ds_read_b64_tr_b16 v[170:171], v38 offset:3072
    s_add_u32 s71, s72, 21504
    buffer_load_dwordx4 v[148:151], v0, s[20:23], s71 offen sc1
    v_mfma_f32_32x32x16_bf16 v[240:255], v[180:183], v[120:123], v[240:255]
    ds_read_b64_tr_b16 v[172:173], v39 offset:2048
    ds_read_b64_tr_b16 v[174:175], v39 offset:3072
    s_waitcnt vmcnt(6) lgkmcnt(8)
    v_mfma_f32_32x32x16_bf16 v[224:239], v[184:187], v[124:127], v[224:239]
    ds_read_b64_tr_b16 v[176:177], v38 offset:4096
    ds_read_b64_tr_b16 v[178:179], v38 offset:5120
    v_mfma_f32_32x32x16_bf16 v[240:255], v[188:191], v[124:127], v[240:255]
    ds_read_b64_tr_b16 v[180:181], v39 offset:4096
    ds_read_b64_tr_b16 v[182:183], v39 offset:5120
    s_waitcnt vmcnt(5) lgkmcnt(8)
    v_mfma_f32_32x32x16_bf16 v[224:239], v[160:163], v[128:131], v[224:239]
    ds_read_b64_tr_b16 v[184:185], v38 offset:6144
    ds_read_b64_tr_b16 v[186:187], v38 offset:7168
    v_mfma_f32_32x32x16_bf16 v[240:255], v[164:167], v[128:131], v[240:255]
    ds_read_b64_tr_b16 v[188:189], v39 offset:6144
    ds_read_b64_tr_b16 v[190:191], v39 offset:7168
    s_waitcnt vmcnt(4) lgkmcnt(8)
    v_mfma_f32_32x32x16_bf16 v[224:239], v[168:171], v[132:135], v[224:239]
    ds_read_b64_tr_b16 v[160:161], v38 offset:8192
    ds_read_b64_tr_b16 v[162:163], v38 offset:9216
    v_mfma_f32_32x32x16_bf16 v[240:255], v[172:175], v[132:135], v[240:255]
    ds_read_b64_tr_b16 v[164:165], v39 offset:8192
    ds_read_b64_tr_b16 v[166:167], v39 offset:9216
    s_waitcnt vmcnt(3) lgkmcnt(8)
    v_mfma_f32_32x32x16_bf16 v[224:239], v[176:179], v[136:139], v[224:239]
    ds_read_b64_tr_b16 v[168:169], v38 offset:10240
    ds_read_b64_tr_b16 v[170:171], v38 offset:11264
    v_mfma_f32_32x32x16_bf16 v[240:255], v[180:183], v[136:139], v[240:255]
    ds_read_b64_tr_b16 v[172:173], v39 offset:10240
    ds_read_b64_tr_b16 v[174:175], v39 offset:11264
    s_waitcnt vmcnt(2) lgkmcnt(8)
    v_mfma_f32_32x32x16_bf16 v[224:239], v[184:187], v[140:143], v[224:239]
    v_mfma_f32_32x32x16_bf16 v[240:255], v[188:191], v[140:143], v[240:255]
    s_waitcnt vmcnt(1) lgkmcnt(4)
    v_mfma_f32_32x32x16_bf16 v[224:239], v[160:163], v[144:147], v[224:239]
    v_mfma_f32_32x32x16_bf16 v[240:255], v[164:167], v[144:147], v[240:255]
    s_waitcnt vmcnt(0) lgkmcnt(0)
    v_mfma_f32_32x32x16_bf16 v[224:239], v[168:171], v[148:151], v[224:239]
    v_mfma_f32_32x32x16_bf16 v[240:255], v[172:175], v[148:151], v[240:255]
    v_accvgpr_read_b32 v65, a240
    v_accvgpr_read_b32 v67, a241
    v_accvgpr_read_b32 v69, a242
    v_accvgpr_read_b32 v71, a243
    v_accvgpr_read_b32 v73, a244
    v_accvgpr_read_b32 v75, a245
    v_accvgpr_read_b32 v77, a246
    v_accvgpr_read_b32 v79, a247
    v_lshlrev_b32 v64, 16, v65
    v_lshlrev_b32 v66, 16, v67
    v_lshlrev_b32 v68, 16, v69
    v_lshlrev_b32 v70, 16, v71
    v_lshlrev_b32 v72, 16, v73
    ds_write_b128 v2, v[240:243] offset:4096
    v_lshlrev_b32 v74, 16, v75
    ds_write_b128 v2, v[244:247] offset:5120
    v_lshlrev_b32 v76, 16, v77
    ds_write_b128 v2, v[248:251] offset:6144
    v_lshlrev_b32 v78, 16, v79
    ds_write_b128 v2, v[252:255] offset:7168
    v_and_b32 v65, 0xffff0000, v65
    v_and_b32 v67, 0xffff0000, v67
    v_and_b32 v69, 0xffff0000, v69
    v_and_b32 v71, 0xffff0000, v71
    v_and_b32 v73, 0xffff0000, v73
    v_and_b32 v75, 0xffff0000, v75
    v_and_b32 v77, 0xffff0000, v77
    v_and_b32 v79, 0xffff0000, v79
    s_mov_b32 s68, 0xbfb8aa3b
    v_lshl_add_u32 v62, v57, 3, v62
    s_waitcnt lgkmcnt(0)
    s_barrier
    ds_read_b128 v[240:243], v3 offset:4096
    ds_read_b128 v[244:247], v3 offset:5120
    ds_read_b128 v[248:251], v3 offset:6144
    ds_read_b128 v[252:255], v3 offset:7168
    ds_read_b128 v[208:211], v3 offset:0
    ds_read_b128 v[212:215], v3 offset:1024
    ds_read_b128 v[216:219], v3 offset:2048
    ds_read_b128 v[220:223], v3 offset:3072
    s_waitcnt lgkmcnt(4)
    v_pk_add_f32 v[224:225], v[224:225], v[240:241]
    v_pk_add_f32 v[226:227], v[226:227], v[242:243]
    v_pk_add_f32 v[228:229], v[228:229], v[244:245]
    v_pk_add_f32 v[230:231], v[230:231], v[246:247]
    v_pk_add_f32 v[232:233], v[232:233], v[248:249]
    v_pk_add_f32 v[234:235], v[234:235], v[250:251]
    v_pk_add_f32 v[236:237], v[236:237], v[252:253]
    v_pk_add_f32 v[238:239], v[238:239], v[254:255]
    v_pk_mul_f32 v[96:97], v[224:225], s[68:69] op_sel_hi:[1,0]
    v_pk_mul_f32 v[98:99], v[226:227], s[68:69] op_sel_hi:[1,0]
    v_pk_mul_f32 v[100:101], v[228:229], s[68:69] op_sel_hi:[1,0]
    v_pk_mul_f32 v[102:103], v[230:231], s[68:69] op_sel_hi:[1,0]
    v_pk_mul_f32 v[104:105], v[232:233], s[68:69] op_sel_hi:[1,0]
    v_pk_mul_f32 v[106:107], v[234:235], s[68:69] op_sel_hi:[1,0]
    v_pk_mul_f32 v[108:109], v[236:237], s[68:69] op_sel_hi:[1,0]
    v_pk_mul_f32 v[110:111], v[238:239], s[68:69] op_sel_hi:[1,0]
    v_exp_f32 v96, v96
    v_exp_f32 v97, v97
    v_exp_f32 v98, v98
    v_exp_f32 v99, v99
    v_exp_f32 v100, v100
    v_exp_f32 v101, v101
    v_exp_f32 v102, v102
    v_exp_f32 v103, v103
    s_waitcnt lgkmcnt(0)
    v_pk_add_f32 v[192:193], v[192:193], v[208:209]
    v_pk_add_f32 v[194:195], v[194:195], v[210:211]
    v_pk_add_f32 v[196:197], v[196:197], v[212:213]
    v_pk_add_f32 v[198:199], v[198:199], v[214:215]
    v_pk_add_f32 v[96:97], v[96:97], 1.0 op_sel_hi:[1,0]
    v_pk_add_f32 v[98:99], v[98:99], 1.0 op_sel_hi:[1,0]
    v_pk_add_f32 v[100:101], v[100:101], 1.0 op_sel_hi:[1,0]
    v_pk_add_f32 v[102:103], v[102:103], 1.0 op_sel_hi:[1,0]
    v_rcp_f32 v96, v96
    v_rcp_f32 v97, v97
    v_rcp_f32 v98, v98
    v_rcp_f32 v99, v99
    v_rcp_f32 v100, v100
    v_rcp_f32 v101, v101
    v_rcp_f32 v102, v102
    v_rcp_f32 v103, v103
    v_pk_mul_f32 v[192:193], v[192:193], v[224:225]
    v_pk_mul_f32 v[194:195], v[194:195], v[226:227]
    v_pk_mul_f32 v[196:197], v[196:197], v[228:229]
    v_pk_mul_f32 v[198:199], v[198:199], v[230:231]
    v_pk_fma_f32 v[64:65], v[192:193], v[96:97], v[64:65]
    v_pk_fma_f32 v[66:67], v[194:195], v[98:99], v[66:67]
    v_pk_fma_f32 v[68:69], v[196:197], v[100:101], v[68:69]
    v_pk_fma_f32 v[70:71], v[198:199], v[102:103], v[70:71]
    v_cvt_pk_bf16_f32 v112, v64, v65
    v_cvt_pk_bf16_f32 v113, v66, v67
    v_cvt_pk_bf16_f32 v114, v68, v69
    v_cvt_pk_bf16_f32 v115, v70, v71
    s_nop 1
    v_permlane32_swap_b32 v112, v114
    v_permlane32_swap_b32 v113, v115
    buffer_store_dwordx4 v[112:115], v62, s[24:27], s78 offen offset:0
    v_exp_f32 v104, v104
    v_exp_f32 v105, v105
    v_exp_f32 v106, v106
    v_exp_f32 v107, v107
    v_exp_f32 v108, v108
    v_exp_f32 v109, v109
    v_exp_f32 v110, v110
    v_exp_f32 v111, v111
    v_pk_add_f32 v[200:201], v[200:201], v[216:217]
    v_pk_add_f32 v[202:203], v[202:203], v[218:219]
    v_pk_add_f32 v[204:205], v[204:205], v[220:221]
    v_pk_add_f32 v[206:207], v[206:207], v[222:223]
    v_pk_add_f32 v[104:105], v[104:105], 1.0 op_sel_hi:[1,0]
    v_pk_add_f32 v[106:107], v[106:107], 1.0 op_sel_hi:[1,0]
    v_pk_add_f32 v[108:109], v[108:109], 1.0 op_sel_hi:[1,0]
    v_pk_add_f32 v[110:111], v[110:111], 1.0 op_sel_hi:[1,0]
    v_rcp_f32 v104, v104
    v_rcp_f32 v105, v105
    v_rcp_f32 v106, v106
    v_rcp_f32 v107, v107
    v_rcp_f32 v108, v108
    v_rcp_f32 v109, v109
    v_rcp_f32 v110, v110
    v_rcp_f32 v111, v111
    v_pk_mul_f32 v[200:201], v[200:201], v[232:233]
    v_pk_mul_f32 v[202:203], v[202:203], v[234:235]
    v_pk_mul_f32 v[204:205], v[204:205], v[236:237]
    v_pk_mul_f32 v[206:207], v[206:207], v[238:239]
    v_pk_fma_f32 v[72:73], v[200:201], v[104:105], v[72:73]
    v_pk_fma_f32 v[74:75], v[202:203], v[106:107], v[74:75]
    v_pk_fma_f32 v[76:77], v[204:205], v[108:109], v[76:77]
    v_pk_fma_f32 v[78:79], v[206:207], v[110:111], v[78:79]
    v_cvt_pk_bf16_f32 v116, v72, v73
    v_cvt_pk_bf16_f32 v117, v74, v75
    v_cvt_pk_bf16_f32 v118, v76, v77
    v_cvt_pk_bf16_f32 v119, v78, v79
    s_nop 1
    v_permlane32_swap_b32 v116, v118
    v_permlane32_swap_b32 v117, v119
    buffer_store_dwordx4 v[116:119], v62, s[24:27], s78 offen offset:32
    s_or_b32 s68, s2, s48
    s_cmp_eq_u32 s68, 0
    s_cbranch_scc0 Lep_56
    s_mov_b32 s80, 0
    s_mov_b32 s69, 12976128
    s_branch Lpc_58
Lpp_57:
    buffer_load_dword v8, v5, s[20:23], s69 offen offset:0 sc1
    buffer_load_dword v9, v5, s[20:23], s69 offen offset:512 sc1
    buffer_load_dword v10, v5, s[20:23], s69 offen offset:1024 sc1
    buffer_load_dword v11, v5, s[20:23], s69 offen offset:1536 sc1
    s_add_u32 s80, s80, 1
    s_waitcnt vmcnt(0)
Lpc_58:
    v_xor_b32 v8, s53, v8
    v_xor_b32 v9, s53, v9
    v_xor_b32 v10, s53, v10
    v_xor_b32 v11, s53, v11
    v_or_b32 v8, v8, v9
    v_or3_b32 v8, v8, v10, v11
    v_cmp_ne_u32 vcc, 0, v8
    s_cmp_gt_u32 s80, 20000
    s_cbranch_scc1 Lep_56
    s_and_b64 vcc, vcc, exec
    s_cbranch_scc1 Lpp_57
    s_mov_b32 s69, 0
    v_mov_b32 v14, s53
    buffer_store_dword v14, v61, s[20:23], s69 offen sc1
Lep_56:
    s_endpgm
Lz1_4:
    v_cvt_pk_bf16_f32 v208, v64, v65
    v_cvt_pk_bf16_f32 v209, v66, v67
    v_cvt_pk_bf16_f32 v210, v68, v69
    v_cvt_pk_bf16_f32 v211, v70, v71
    buffer_store_dwordx4 v[208:211], v0, s[20:23], s64 offen offset:0 sc1
    v_cvt_pk_bf16_f32 v212, v72, v73
    v_cvt_pk_bf16_f32 v213, v74, v75
    v_cvt_pk_bf16_f32 v214, v76, v77
    v_cvt_pk_bf16_f32 v215, v78, v79
    buffer_store_dwordx4 v[212:215], v0, s[20:23], s64 offen offset:1024 sc1
    v_cvt_pk_bf16_f32 v216, v80, v81
    v_cvt_pk_bf16_f32 v217, v82, v83
    v_cvt_pk_bf16_f32 v218, v84, v85
    v_cvt_pk_bf16_f32 v219, v86, v87
    buffer_store_dwordx4 v[216:219], v0, s[20:23], s64 offen offset:2048 sc1
    v_cvt_pk_bf16_f32 v220, v88, v89
    v_cvt_pk_bf16_f32 v221, v90, v91
    v_cvt_pk_bf16_f32 v222, v92, v93
    v_cvt_pk_bf16_f32 v223, v94, v95
    buffer_store_dwordx4 v[220:223], v0, s[20:23], s64 offen offset:3072 sc1
    s_branch Lj_5
Lre_7:
    s_mov_b32 s80, 0
Lr2_59:
    s_add_u32 s73, s82, 0
    buffer_load_dwordx4 v[96:99], v12, s[20:23], s73 offen sc1
    s_add_u32 s73, s82, 4096
    buffer_load_dwordx4 v[100:103], v12, s[20:23], s73 offen sc1
    s_add_u32 s73, s82, 8192
    buffer_load_dwordx4 v[104:107], v12, s[20:23], s73 offen sc1
    s_add_u32 s73, s82, 12288
    buffer_load_dwordx4 v[108:111], v12, s[20:23], s73 offen sc1
    s_add_u32 s73, s82, 16384
    buffer_load_dwordx4 v[112:115], v12, s[20:23], s73 offen sc1
    s_add_u32 s73, s82, 20480
    buffer_load_dwordx4 v[116:119], v13, s[20:23], s73 offen sc1
    s_add_u32 s80, s80, 1
    s_cmp_gt_u32 s80, 20000
    s_waitcnt vmcnt(0)
    s_cbranch_scc1 Lok_6
    v_cmp_eq_u32 vcc, 0, v57
    v_xor_b32 v4, v98, v102
    v_xor_b32 v5, v106, v110
    v_cndmask_b32 v6, v114, v118, vcc
    v_or_b32 v4, v4, v5
    v_xor_b32 v5, v98, v106
    v_xor_b32 v6, v6, v114
    v_or3_b32 v4, v4, v5, v6
    v_xor_b32 v5, v98, v114
    v_xor_b32 v6, s53, v98
    v_or3_b32 v4, v4, v5, v6
    v_cmp_ne_u32 vcc, 0, v4
    s_nop 1
    s_and_b64 vcc, vcc, exec
    s_cbranch_scc0 Lok_6
    s_sleep 2
    s_branch Lr2_59
Los_51:
    s_waitcnt vmcnt(0)
    v_mov_b32 v14, s53
    buffer_store_dword v14, v61, s[20:23], s6 offen sc1
    s_mov_b32 s6, 1073741824
    s_mov_b32 s80, 0
Lo2_60:
    buffer_load_dword v27, v41, s[20:23], s5 offen sc1
    s_add_u32 s80, s80, 1
    s_cmp_gt_u32 s80, 20000
    s_waitcnt vmcnt(0)
    s_cbranch_scc1 Lob_52
    v_cmp_ne_u32 vcc, s53, v27
    s_nop 1
    s_and_b32 s68, vcc_lo, 15
    s_cbranch_scc0 Lob_52
    s_sleep 2
    s_branch Lo2_60
Ls_2:
    s_mov_b32 s80, 0
Lt_61:
    buffer_load_dwordx4 v[240:243], v56, s[20:23], s79 offen sc1
    s_add_u32 s80, s80, 1
    s_cmp_gt_u32 s80, 20000
    s_waitcnt vmcnt(0)
    s_cbranch_scc1 Lb_3
    v_cmp_ne_u32 vcc, s53, v243
    s_nop 1
    s_and_b32 s68, vcc_lo, -1
    s_cbranch_scc0 Lb_3
    s_sleep 2
    s_branch Lt_61
Ls_11:
    s_mov_b32 s80, 0
Lt_62:
    buffer_load_dword v59, v56, s[20:23], s47 offen sc1
    s_add_u32 s80, s80, 1
    s_cmp_gt_u32 s80, 20000
    s_waitcnt vmcnt(0)
    s_cbranch_scc1 Lb_12
    v_cmp_eq_u32 vcc, s53, v59
    s_nop 1
    s_or_b32 s76, s76, vcc_lo
    s_andn2_b32 s68, 15, s76
    s_cbranch_scc0 Lb_12
    s_sleep 2
    s_branch Lt_62
Ls_13:
    s_mov_b32 s80, 0
Lt_63:
    buffer_load_dword v59, v56, s[20:23], s47 offen sc1
    s_add_u32 s80, s80, 1
    s_cmp_gt_u32 s80, 20000
    s_waitcnt vmcnt(0)
    s_cbranch_scc1 Lb_14
    v_cmp_eq_u32 vcc, s53, v59
    s_nop 1
    s_or_b32 s76, s76, vcc_lo
    s_andn2_b32 s68, 240, s76
    s_cbranch_scc0 Lb_14
    s_sleep 2
    s_branch Lt_63
Ls_15:
    s_mov_b32 s80, 0
Lt_64:
    buffer_load_dword v15, v61, s[20:23], s64 offen sc1
    s_add_u32 s80, s80, 1
    s_cmp_gt_u32 s80, 20000
    s_waitcnt vmcnt(0)
    s_cbranch_scc1 Lb_16
    v_cmp_ne_u32 vcc, s53, v15
    s_nop 1
    s_and_b32 s68, vcc_lo, 1
    s_cbranch_scc0 Lb_16
    s_sleep 2
    s_branch Lt_64
Ls_17:
    s_mov_b32 s80, 0
Lt_65:
    buffer_load_dword v59, v56, s[20:23], s47 offen sc1
    s_add_u32 s80, s80, 1
    s_cmp_gt_u32 s80, 20000
    s_waitcnt vmcnt(0)
    s_cbranch_scc1 Lb_18
    v_cmp_eq_u32 vcc, s53, v59
    s_nop 1
    s_or_b32 s76, s76, vcc_lo
    s_andn2_b32 s68, 3840, s76
    s_cbranch_scc0 Lb_18
    s_sleep 2
    s_branch Lt_65
Ls_19:
    s_mov_b32 s80, 0
Lt_66:
    buffer_load_dword v59, v56, s[20:23], s47 offen sc1
    s_add_u32 s80, s80, 1
    s_cmp_gt_u32 s80, 20000
    s_waitcnt vmcnt(0)
    s_cbranch_scc1 Lb_20
    v_cmp_eq_u32 vcc, s53, v59
    s_nop 1
    s_or_b32 s76, s76, vcc_lo
    s_andn2_b32 s68, 61440, s76
    s_cbranch_scc0 Lb_20
    s_sleep 2
    s_branch Lt_66
Ls_21:
    s_mov_b32 s80, 0
Lt_67:
    buffer_load_dword v59, v56, s[20:23], s47 offen sc1
    s_add_u32 s80, s80, 1
    s_cmp_gt_u32 s80, 20000
    s_waitcnt vmcnt(0)
    s_cbranch_scc1 Lb_22
    v_cmp_eq_u32 vcc, s53, v59
    s_nop 1
    s_or_b32 s76, s76, vcc_lo
    s_andn2_b32 s68, 983040, s76
    s_cbranch_scc0 Lb_22
    s_sleep 2
    s_branch Lt_67
Ls_23:
    s_mov_b32 s80, 0
Lt_68:
    buffer_load_dword v59, v56, s[20:23], s47 offen sc1
    s_add_u32 s80, s80, 1
    s_cmp_gt_u32 s80, 20000
    s_waitcnt vmcnt(0)
    s_cbranch_scc1 Lb_24
    v_cmp_eq_u32 vcc, s53, v59
    s_nop 1
    s_or_b32 s76, s76, vcc_lo
    s_andn2_b32 s68, 15728640, s76
    s_cbranch_scc0 Lb_24
    s_sleep 2
    s_branch Lt_68
Ls_25:
    s_mov_b32 s80, 0
Lt_69:
    buffer_load_dword v59, v56, s[20:23], s47 offen sc1
    s_add_u32 s80, s80, 1
    s_cmp_gt_u32 s80, 20000
    s_waitcnt vmcnt(0)
    s_cbranch_scc1 Lb_26
    v_cmp_eq_u32 vcc, s53, v59
    s_nop 1
    s_or_b32 s76, s76, vcc_lo
    s_andn2_b32 s68, 251658240, s76
    s_cbranch_scc0 Lb_26
    s_sleep 2
    s_branch Lt_69
Ls_27:
    s_mov_b32 s80, 0
Lt_70:
    buffer_load_dword v59, v56, s[20:23], s47 offen sc1
    s_add_u32 s80, s80, 1
    s_cmp_gt_u32 s80, 20000
    s_waitcnt vmcnt(0)
    s_cbranch_scc1 Lb_28
    v_cmp_eq_u32 vcc, s53, v59
    s_nop 1
    s_or_b32 s76, s76, vcc_lo
    s_andn2_b32 s68, 4026531840, s76
    s_cbranch_scc0 Lb_28
    s_sleep 2
    s_branch Lt_70
Ls_29:
    s_mov_b32 s80, 0
Lt_71:
    buffer_load_dword v27, v26, s[20:23], s64 offen sc1
    s_add_u32 s80, s80, 1
    s_cmp_gt_u32 s80, 20000
    s_waitcnt vmcnt(0)
    s_cbranch_scc1 Lb_30
    v_cmp_ne_u32 vcc, s53, v27
    s_nop 1
    s_and_b32 s68, vcc_lo, 7
    s_cbranch_scc0 Lb_30
    s_sleep 2
    s_branch Lt_71
Ls_31:
    s_mov_b32 s80, 0
Lt_72:
    buffer_load_dword v59, v56, s[20:23], s47 offen sc1
    s_add_u32 s80, s80, 1
    s_cmp_gt_u32 s80, 20000
    s_waitcnt vmcnt(0)
    s_cbranch_scc1 Lb_32
    v_cmp_eq_u32 vcc, s53, v59
    s_nop 1
    s_or_b32 s76, s76, vcc_lo
    s_andn2_b32 s68, 15, s76
    s_cbranch_scc0 Lb_32
    s_sleep 2
    s_branch Lt_72
Ls_33:
    s_mov_b32 s80, 0
Lt_73:
    buffer_load_dword v59, v56, s[20:23], s47 offen sc1
    s_add_u32 s80, s80, 1
    s_cmp_gt_u32 s80, 20000
    s_waitcnt vmcnt(0)
    s_cbranch_scc1 Lb_34
    v_cmp_eq_u32 vcc, s53, v59
    s_nop 1
    s_or_b32 s76, s76, vcc_lo
    s_andn2_b32 s68, 240, s76
    s_cbranch_scc0 Lb_34
    s_sleep 2
    s_branch Lt_73
Ls_35:
    s_mov_b32 s80, 0
Lt_74:
    buffer_load_dword v59, v56, s[20:23], s47 offen sc1
    s_add_u32 s80, s80, 1
    s_cmp_gt_u32 s80, 20000
    s_waitcnt vmcnt(0)
    s_cbranch_scc1 Lb_36
    v_cmp_eq_u32 vcc, s53, v59
    s_nop 1
    s_or_b32 s76, s76, vcc_lo
    s_andn2_b32 s68, 3840, s76
    s_cbranch_scc0 Lb_36
    s_sleep 2
    s_branch Lt_74
Ls_37:
    s_mov_b32 s80, 0
Lt_75:
    buffer_load_dword v59, v56, s[20:23], s47 offen sc1
    s_add_u32 s80, s80, 1
    s_cmp_gt_u32 s80, 20000
    s_waitcnt vmcnt(0)
    s_cbranch_scc1 Lb_38
    v_cmp_eq_u32 vcc, s53, v59
    s_nop 1
    s_or_b32 s76, s76, vcc_lo
    s_andn2_b32 s68, 61440, s76
    s_cbranch_scc0 Lb_38
    s_sleep 2
    s_branch Lt_75
Ls_39:
    s_mov_b32 s80, 0
Lt_76:
    buffer_load_dword v59, v56, s[20:23], s47 offen sc1
    s_add_u32 s80, s80, 1
    s_cmp_gt_u32 s80, 20000
    s_waitcnt vmcnt(0)
    s_cbranch_scc1 Lb_40
    v_cmp_eq_u32 vcc, s53, v59
    s_nop 1
    s_or_b32 s76, s76, vcc_lo
    s_andn2_b32 s68, 983040, s76
    s_cbranch_scc0 Lb_40
    s_sleep 2
    s_branch Lt_76
Ls_41:
    s_mov_b32 s80, 0
Lt_77:
    buffer_load_dword v59, v56, s[20:23], s47 offen sc1
    s_add_u32 s80, s80, 1
    s_cmp_gt_u32 s80, 20000
    s_waitcnt vmcnt(0)
    s_cbranch_scc1 Lb_42
    v_cmp_eq_u32 vcc, s53, v59
    s_nop 1
    s_or_b32 s76, s76, vcc_lo
    s_andn2_b32 s68, 15728640, s76
    s_cbranch_scc0 Lb_42
    s_sleep 2
    s_branch Lt_77
Ls_43:
    s_mov_b32 s80, 0
Lt_78:
    buffer_load_dword v153, v152, s[20:23], s62 offen sc1
    s_add_u32 s80, s80, 1
    s_cmp_gt_u32 s80, 20000
    s_waitcnt vmcnt(0)
    s_cbranch_scc1 Lb_44
    v_cmp_ne_u32 vcc, s53, v153
    s_nop 1
    s_and_b32 s68, vcc_lo, 65535
    s_cbranch_scc0 Lb_44
    s_sleep 2
    s_branch Lt_78
Ls_45:
    s_mov_b32 s80, 0
Lt_79:
    buffer_load_dword v59, v56, s[20:23], s47 offen sc1
    s_add_u32 s80, s80, 1
    s_cmp_gt_u32 s80, 20000
    s_waitcnt vmcnt(0)
    s_cbranch_scc1 Lb_46
    v_cmp_eq_u32 vcc, s53, v59
    s_nop 1
    s_or_b32 s76, s76, vcc_lo
    s_andn2_b32 s68, 251658240, s76
    s_cbranch_scc0 Lb_46
    s_sleep 2
    s_branch Lt_79
Ls_47:
    s_mov_b32 s80, 0
Lt_80:
    buffer_load_dword v59, v56, s[20:23], s47 offen sc1
    s_add_u32 s80, s80, 1
    s_cmp_gt_u32 s80, 20000
    s_waitcnt vmcnt(0)
    s_cbranch_scc1 Lb_48
    v_cmp_eq_u32 vcc, s53, v59
    s_nop 1
    s_or_b32 s76, s76, vcc_lo
    s_andn2_b32 s68, 4026531840, s76
    s_cbranch_scc0 Lb_48
    s_sleep 2
    s_branch Lt_80
Ls_49:
    s_mov_b32 s80, 0
Lt_81:
    buffer_load_dword v27, v26, s[20:23], s64 offen sc1
    s_add_u32 s80, s80, 1
    s_cmp_gt_u32 s80, 20000
    s_waitcnt vmcnt(0)
    s_cbranch_scc1 Lb_50
    v_cmp_ne_u32 vcc, s53, v27
    s_nop 1
    s_and_b32 s68, vcc_lo, 7
    s_cbranch_scc0 Lb_50
    s_sleep 2
    s_branch Lt_81
Ls_53:
    s_mov_b32 s80, 0
Lt_82:
    buffer_load_dword v27, v40, s[20:23], s82 offen sc1
    s_add_u32 s80, s80, 1
    s_cmp_gt_u32 s80, 20000
    s_waitcnt vmcnt(0)
    s_cbranch_scc1 Lb_54
    v_cmp_ne_u32 vcc, s53, v27
    s_nop 1
    s_and_b32 s68, vcc_lo, 65535
    s_cbranch_scc0 Lb_54
    s_sleep 2
    s_branch Lt_82
L_end:
    s_endpgm
.fill 256, 4, 0xbf800000
.section .rodata,"a"
.p2align 6
.amdhsa_kernel recurrent_scan__linear_kernel_hedgehog__mixer_gmlp__prompt_kernel
  .amdhsa_next_free_vgpr 512
  .amdhsa_next_free_sgpr 102
  .amdhsa_accum_offset 256
  .amdhsa_group_segment_fixed_size 0
  .amdhsa_kernarg_size 96
  .amdhsa_user_sgpr_count 2
  .amdhsa_user_sgpr_kernarg_segment_ptr 1
  .amdhsa_system_sgpr_workgroup_id_x 1
.end_amdhsa_kernel
```
